```python
import torch

def _softmax(x, axis=-1):
    return torch.softmax(x, dim=axis)
def _gelu(x):
    return torch.nn.functional.gelu(x, approximate="tanh")
def _silu(x):
    return torch.nn.functional.silu(x)
def _sigmoid(x):
    return torch.sigmoid(x)
def _layernorm(x, axis=-1, eps=1e-5):
    m = x.mean(dim=axis, keepdim=True)
    v = x.var(dim=axis, keepdim=True, unbiased=False)
    return (x - m) / torch.sqrt(v + eps)
def _scatter_add(tgt, idx, src, axis=0):
    return tgt.clone().index_add_(axis, idx, src)
def _segment_sum(src, seg, n):
    out = torch.zeros((n,) + src.shape[1:], dtype=src.dtype)
    return out.index_add_(0, seg, src)
def _pad(x, pw):
    flat = tuple(v for pair in reversed(pw) for v in pair)
    return torch.nn.functional.pad(x, flat)

kernel_name = 'sequential_preLN__ssm_conv_h3__dense_activation_relu__prompt'

def setup_inputs():

    _w = (lambda a: (lambda t: t.to(torch.bfloat16) if t.is_floating_point() else t)(torch.as_tensor(a)))
    def _A_setup():
        B, S, D = 1, 2048, 576
        ks = 4
        return {
            "q": _w((lambda *s: torch.randn(*s, dtype=torch.bfloat16) * 0.05)(B, S, D)),
            "k": _w((lambda *s: torch.randn(*s, dtype=torch.bfloat16) * 0.4)(B, S, D)),
            "v": _w((lambda *s: torch.randn(*s, dtype=torch.bfloat16) * 0.4)(B, S, D)),
            "shift_k": _w((lambda *s: torch.randn(*s, dtype=torch.bfloat16) * 0.4)(D, ks) * 0.5),
            "ssm_k": _w((lambda *s: torch.randn(*s, dtype=torch.bfloat16) * 0.4)(D, S) * (1.0 / S ** 0.5)),
            "ssm_D": _w((lambda *s: torch.randn(*s, dtype=torch.bfloat16) * 0.4)(D)),
        }
    _A_in = _A_setup()

    def _B_setup():
        B, S, D, Dff = 1, 2048, 576, 4608
        return {
            "x": _w((lambda *s: torch.randn(*s, dtype=torch.bfloat16) * 0.05)(B, S, D)),
            "w1": _w((lambda *s: torch.randn(*s, dtype=torch.bfloat16) * 0.05)(D, Dff)),
            "w2": _w((lambda *s: torch.randn(*s, dtype=torch.bfloat16) * 0.05)(Dff, D)),
        }
    _B_in = _B_setup()

    return {
        "A_q": _A_in["q"],
        "A_k": _A_in["k"],
        "A_v": _A_in["v"],
        "A_shift_k": _A_in["shift_k"],
        "A_ssm_k": _A_in["ssm_k"],
        "A_ssm_D": _A_in["ssm_D"],
        "B_x": _B_in["x"],
        "B_w1": _B_in["w1"],
        "B_w2": _B_in["w2"],
    }

def reference(A_q, A_k, A_v, A_shift_k, A_ssm_k, A_ssm_D, B_x, B_w1, B_w2):
    def _A_ref(q, k, v, shift_k, ssm_k, ssm_D):
        B, S, D = q.shape
        ks = shift_k.shape[-1]
        k_pad = _pad(k, ((0, 0), (ks - 1, 0), (0, 0)))
        k_shift = torch.zeros_like(k)
        for t in range(ks):
            k_shift = k_shift + k_pad[:, t:t + S, :] * shift_k[:, ks - 1 - t][None, None, :]
        kv = k_shift * v
        L = 2 * S
        kv_pad = _pad(kv, ((0, 0), (0, S), (0, 0)))
        kf_pad = _pad(ssm_k, ((0, 0), (0, S)))
        kv_f = (lambda x, axes=(-2,-1): torch.fft.rfft2(x.float(), dim=axes))(kv_pad[:, None, :, :], axes=(1, 2))
        kf_f = (lambda x, axes=(-2,-1): torch.fft.rfft2(x.float(), dim=axes))(kf_pad[:, None, :], axes=(1, 2))
        kf_f = (lambda x, *d: x.permute(*d))(kf_f, 1, 2, 0)
        y_f = kv_f * kf_f[None, :, :, :]
        y = (lambda x, s, axes=(-2,-1): torch.fft.irfft2(x, s=s, dim=axes).to(torch.bfloat16))(y_f, (1, L), axes=(1, 2))[:, 0, :S, :]
        y = y + kv * ssm_D[None, None, :]
        return q * y

    def _B_ref(x, w1, w2):
        h = torch.einsum("bsd,df->bsf", x, w1)
        zero = torch.zeros_like(h)
        h = torch.maximum(h, zero)
        return torch.einsum("bsf,fd->bsd", h, w2)

    x = A_q
    h = x + _A_ref(_layernorm(x, axis=-1), A_k, A_v, A_shift_k, A_ssm_k, A_ssm_D)
    h2 = h + _B_ref(_layernorm(h, axis=-1), B_w1, B_w2)
    return h2
```

```asm
; @launch grid=(256,1,1) block=(256,1,1) lds=163840
.amdgcn_target "amdgcn-amd-amdhsa--gfx950"
.text
.globl sequential_preLN__ssm_conv_h3__dense_activation_relu__prompt_kernel
.p2align 8
.type sequential_preLN__ssm_conv_h3__dense_activation_relu__prompt_kernel,@function
sequential_preLN__ssm_conv_h3__dense_activation_relu__prompt_kernel:
    s_getpc_b64 s[76:77]
    s_load_dwordx16 s[16:31], s[0:1], 0
    s_load_dwordx8 s[32:39], s[0:1], 64
    s_cmp_ge_u32 s2, 256
    s_cbranch_scc1 sequential_preLN__ssm_conv_h3__dense_activation_relu__prompt_kernel_end1
    v_lshrrev_b32 v1, 6, v0
    v_and_b32 v2, 63, v0
    v_readfirstlane_b32 s5, v1
    v_lshlrev_b32 v4, 4, v2
    s_cmp_lg_u32 s5, 3
    s_cbranch_scc1 sequential_preLN__ssm_conv_h3__dense_activation_relu__prompt_kernel_skip2
    s_bfe_u32 s3, s2, 0x20003
    s_mul_i32 s3, s3, 9216
    v_add_u32 v3, s3, v4
    global_load_dword v1, v3, s[76:77] offset:0
    global_load_dword v1, v3, s[76:77] offset:1024
    global_load_dword v1, v3, s[76:77] offset:2048
    global_load_dword v1, v3, s[76:77] offset:3072
    v_add_u32 v3, 0x1000, v3
    global_load_dword v1, v3, s[76:77] offset:0
    global_load_dword v1, v3, s[76:77] offset:1024
    global_load_dword v1, v3, s[76:77] offset:2048
    global_load_dword v1, v3, s[76:77] offset:3072
    v_add_u32 v3, 0x1000, v3
    global_load_dword v1, v3, s[76:77] offset:0
sequential_preLN__ssm_conv_h3__dense_activation_relu__prompt_kernel_skip2:
    s_and_b32 s3, s2, 31
    s_lshr_b32 s4, s2, 5
    v_and_b32 v165, 7, v0
    v_lshrrev_b32 v166, 3, v0
    v_mul_u32_u24 v167, 2304, v166
    v_lshl_add_u32 v167, v165, 4, v167
    v_lshlrev_b32 v168, 6, v165
    v_lshrrev_b32 v169, 5, v0
    s_lshl_b32 s6, s2, 3
    v_add_u32 v169, s6, v169
    v_mul_u32_u24 v170, 1152, v169
    v_and_b32 v171, 31, v0
    v_lshl_add_u32 v170, v171, 2, v170
    v_lshlrev_b32 v3, 4, v0
    v_add_u32 v172, -16, v3
    v_cmp_eq_u32 vcc, 0, v0
    v_mov_b32 v173, 0x7f000000
    s_nop 0
    v_cndmask_b32 v172, v172, v173, vcc
    v_and_b32 v5, 15, v2
    v_lshrrev_b32 v6, 4, v2
    s_lshl_b32 s8, s5, 10
    s_lshr_b32 s7, s2, 1
    s_lshl_b32 s7, s7, 2
    s_add_u32 s9, s7, 512
    s_add_u32 s10, s7, 1024
    s_min_u32 s10, s10, 1148
    s_waitcnt lgkmcnt(0)
    s_mov_b32 s40, s16
    s_mov_b32 s41, s17
    s_mov_b32 s42, 0x240000
    s_mov_b32 s43, 0x20000
    s_mov_b32 s64, s38
    s_mov_b32 s65, s39
    s_mov_b32 s66, 0x2900000
    s_mov_b32 s67, 0x20000
    s_load_dword s78, s[26:27], s7
    s_load_dword s79, s[26:27], s9
    s_load_dword s80, s[26:27], s10
    s_cmp_lg_u32 s2, 0
    s_cbranch_scc1 sequential_preLN__ssm_conv_h3__dense_activation_relu__prompt_kernel_skip3
    v_mov_b32 v148, 0
    v_mov_b32 v149, 0
    v_mov_b32 v150, 0
    v_mov_b32 v151, 0
    s_mul_i32 s7, s5, 10240
    s_add_u32 s7, s7, 10289152
    buffer_store_dwordx4 v[148:151], v4, s[64:67], s7 offen offset:0 sc1
    buffer_store_dwordx4 v[148:151], v4, s[64:67], s7 offen offset:1024 sc1
    buffer_store_dwordx4 v[148:151], v4, s[64:67], s7 offen offset:2048 sc1
    buffer_store_dwordx4 v[148:151], v4, s[64:67], s7 offen offset:3072 sc1
    s_add_u32 s7, s7, 4096
    buffer_store_dwordx4 v[148:151], v4, s[64:67], s7 offen offset:0 sc1
    buffer_store_dwordx4 v[148:151], v4, s[64:67], s7 offen offset:1024 sc1
    buffer_store_dwordx4 v[148:151], v4, s[64:67], s7 offen offset:2048 sc1
    buffer_store_dwordx4 v[148:151], v4, s[64:67], s7 offen offset:3072 sc1
    s_add_u32 s7, s7, 4096
    buffer_store_dwordx4 v[148:151], v4, s[64:67], s7 offen offset:0 sc1
    buffer_store_dwordx4 v[148:151], v4, s[64:67], s7 offen offset:1024 sc1
sequential_preLN__ssm_conv_h3__dense_activation_relu__prompt_kernel_skip3:
    buffer_load_dword v200, v170, s[40:43], 0 offen offset:0
    buffer_load_dword v201, v170, s[40:43], 0 offen offset:128
    buffer_load_dword v202, v170, s[40:43], 0 offen offset:256
    buffer_load_dword v203, v170, s[40:43], 0 offen offset:384
    buffer_load_dword v204, v170, s[40:43], 0 offen offset:512
    buffer_load_dword v205, v170, s[40:43], 0 offen offset:640
    buffer_load_dword v206, v170, s[40:43], 0 offen offset:768
    buffer_load_dword v207, v170, s[40:43], 0 offen offset:896
    buffer_load_dword v208, v170, s[40:43], 0 offen offset:1024
    s_mov_b32 s44, s18
    s_mov_b32 s45, s19
    s_mov_b32 s46, 0x240000
    s_mov_b32 s47, 0x20000
    s_mov_b32 s48, s20
    s_mov_b32 s49, s21
    s_mov_b32 s50, 0x240000
    s_mov_b32 s51, 0x20000
    s_mov_b32 s52, s22
    s_mov_b32 s53, s23
    s_mov_b32 s54, 0x1200
    s_mov_b32 s55, 0x20000
    s_mov_b32 s56, s24
    s_mov_b32 s57, s25
    s_mov_b32 s58, 0x240000
    s_mov_b32 s59, 0x20000
    s_mul_i32 s6, s3, 73728
    s_mul_i32 s7, s4, 144
    s_add_u32 s6, s6, s7
    v_add_u32 v174, s6, v167
    v_add_u32 v175, -3456, v174
    v_add_u32 v176, -2304, v174
    v_add_u32 v177, -1152, v174
    s_mul_i32 s7, s4, 576
    buffer_load_dwordx4 v[44:47], v168, s[52:55], s7 offen offset:0
    buffer_load_dwordx4 v[48:51], v168, s[52:55], s7 offen offset:16
    buffer_load_dwordx4 v[52:55], v168, s[52:55], s7 offen offset:32
    buffer_load_dwordx4 v[56:59], v168, s[52:55], s7 offen offset:48
    buffer_load_dwordx4 v[8:11], v175, s[44:47], 0 offen
    buffer_load_dwordx4 v[12:15], v176, s[44:47], 0 offen
    buffer_load_dwordx4 v[16:19], v177, s[44:47], 0 offen
    buffer_load_dwordx4 v[20:23], v174, s[44:47], 0 offen
    buffer_load_dwordx4 v[24:27], v174, s[44:47], 0 offen offset:1152
    buffer_load_dwordx4 v[28:31], v174, s[48:51], 0 offen
    buffer_load_dwordx4 v[32:35], v174, s[48:51], 0 offen offset:1152
    buffer_load_dwordx4 v[36:39], v174, s[40:43], 0 offen
    buffer_load_dwordx4 v[40:43], v174, s[40:43], 0 offen offset:1152
    v_lshrrev_b32 v175, 2, v0
    v_mul_u32_u24 v176, 1152, v175
    v_and_b32 v177, 3, v0
    v_lshl_add_u32 v176, v177, 2, v176
    s_add_u32 s6, s6, 128
    v_add_u32 v176, s6, v176
    v_lshlrev_b32 v178, 4, v177
    buffer_load_dwordx4 a[20:23], v178, s[52:55], s7 offen offset:512
    v_add_u32 v178, -3456, v176
    buffer_load_dword a24, v178, s[44:47], 0 offen
    v_add_u32 v178, -2304, v176
    buffer_load_dword a25, v178, s[44:47], 0 offen
    v_add_u32 v178, -1152, v176
    buffer_load_dword a26, v178, s[44:47], 0 offen
    buffer_load_dword a27, v176, s[44:47], 0 offen
    buffer_load_dword a28, v176, s[48:51], 0 offen
    buffer_load_dword a29, v176, s[40:43], 0 offen
    v_lshlrev_b32 v176, 4, v175
    v_lshl_add_u32 v176, v177, 2, v176
    v_add_u32 v176, 93184, v176
    v_xor_b32 v175, 63, v175
    v_lshlrev_b32 v175, 4, v175
    v_lshl_add_u32 v175, v177, 2, v175
    v_add_u32 v175, 92160, v175
    s_lshl_b32 s11, s2, 12
    s_add_u32 s7, s11, 0
    buffer_load_dwordx4 v[232:235], v172, s[56:59], s7 offen
    buffer_load_dwordx4 v[236:239], v3, s[56:59], s7 offen
    s_add_u32 s7, s11, 1048576
    buffer_load_dwordx4 v[240:243], v172, s[56:59], s7 offen
    buffer_load_dwordx4 v[244:247], v3, s[56:59], s7 offen
    s_cmp_ge_u32 s2, 64
    s_cselect_b32 s7, 0x7f000000, s11
    s_add_u32 s7, s7, 0x200000
    buffer_load_dwordx4 v[248:251], v172, s[56:59], s7 offen
    buffer_load_dwordx4 v[252:255], v3, s[56:59], s7 offen
    s_mov_b32 s68, s34
    s_mov_b32 s69, s35
    s_mov_b32 s70, 0x240000
    s_mov_b32 s71, 0x20000
    s_mov_b32 s72, s36
    s_mov_b32 s73, s37
    s_mov_b32 s74, 0x100
    s_mov_b32 s75, 0x20000
    s_sub_u32 s81, s2, 64
    s_cmp_ge_u32 s81, 144
    s_cbranch_scc1 sequential_preLN__ssm_conv_h3__dense_activation_relu__prompt_kernel_skip4
    s_mov_b32 s13, s81
    s_and_b32 s14, s13, 1
    s_lshr_b32 s15, s13, 1
    s_cmp_ge_u32 s15, 72
    s_cbranch_scc1 sequential_preLN__ssm_conv_h3__dense_activation_relu__prompt_kernel_uw25
    s_mov_b32 s60, s30
    s_mov_b32 s61, s31
    s_mov_b32 s62, 0x510000
    s_mov_b32 s63, 0x20000
    s_mul_i32 s44, s14, 2654208
    s_lshl_b32 s45, s15, 7
    s_add_u32 s44, s44, s45
    s_mov_b32 s46, 9216
    s_lshl_b32 s47, s15, 2
    s_add_u32 s47, s47, s5
    s_mov_b32 s48, 1
    s_branch sequential_preLN__ssm_conv_h3__dense_activation_relu__prompt_kernel_uend6
sequential_preLN__ssm_conv_h3__dense_activation_relu__prompt_kernel_uw25:
    s_mov_b32 s60, s32
    s_mov_b32 s61, s33
    s_mov_b32 s62, 0x510000
    s_mov_b32 s63, 0x20000
    s_sub_u32 s15, s15, 72
    s_mul_i32 s45, s15, 7282
    s_lshr_b32 s45, s45, 16
    s_mul_i32 s46, s45, 9
    s_sub_u32 s46, s15, s46
    s_mul_i32 s44, s45, 663552
    s_lshl_b32 s47, s46, 7
    s_add_u32 s44, s44, s47
    s_mul_i32 s47, s14, 331776
    s_add_u32 s44, s44, s47
    s_lshl_b32 s46, s46, 1
    s_lshr_b32 s47, s5, 1
    s_add_u32 s46, s46, s47
    s_and_b32 s47, s5, 1
    s_lshr_b32 s48, s46, 2
    s_mul_i32 s48, s48, 9
    s_and_b32 s49, s46, 3
    s_lshl_b32 s49, s49, 1
    s_add_u32 s48, s48, s49
    s_add_u32 s48, s48, s47
    s_sub_u32 s49, s46, 16
    s_lshl_b32 s49, s49, 1
    s_add_u32 s49, s49, s47
    s_mul_i32 s49, s49, 9
    s_add_u32 s49, s49, 8
    s_cmp_lt_u32 s46, 16
    s_cselect_b32 s47, s48, s49
    s_mul_i32 s45, s45, 36
    s_add_u32 s47, s47, s45
    s_add_u32 s47, s47, 288
    s_mov_b32 s46, 1152
    s_mov_b32 s48, 0
sequential_preLN__ssm_conv_h3__dense_activation_relu__prompt_kernel_uend6:
    s_mul_i32 s49, s47, 18432
    s_mul_i32 s45, s14, 9216
    s_add_u32 s49, s49, s45
    s_add_u32 s49, s49, 10485760
    s_mul_i32 s45, s14, 18432
    s_lshl_b32 s47, s47, 6
    s_add_u32 s47, s47, s45
    s_add_u32 s47, s47, 10240000
sequential_preLN__ssm_conv_h3__dense_activation_relu__prompt_kernel_skip4:
    v_and_b32 v181, 1, v166
    v_bfe_u32 v182, v166, 2, 2
    v_lshl_or_b32 v181, v182, 1, v181
    v_xor_b32 v181, v181, v165
    v_lshlrev_b32 v182, 8, v166
    v_lshl_add_u32 v182, v181, 4, v182
    v_add_u32 v182, 83968, v182
    v_xor_b32 v181, 7, v181
    v_xor_b32 v183, 31, v166
    v_lshlrev_b32 v183, 8, v183
    v_lshl_add_u32 v183, v181, 4, v183
    v_add_u32 v183, 75776, v183
    v_bfe_u32 v184, v2, 2, 2
    v_bfe_u32 v185, v2, 1, 1
    v_lshl_add_u32 v185, v6, 1, v185
    v_lshl_add_u32 v186, v185, 3, v184
    v_lshlrev_b32 v186, 7, v186
    v_and_b32 v187, 1, v2
    v_lshl_add_u32 v186, v187, 3, v186
    v_add_u32 v186, 75776, v186
    v_lshrrev_b32 v184, 1, v184
    v_and_b32 v187, 3, v185
    v_lshl_or_b32 v184, v187, 1, v184
    v_bfe_u32 v177, v2, 2, 2
    v_lshl_add_u32 v177, v185, 3, v177
    v_lshlrev_b32 v177, 4, v177
    v_and_b32 v187, 1, v2
    v_lshl_add_u32 v177, v187, 3, v177
    s_add_u32 s7, s8, 92160
    v_add_u32 v177, s7, v177
    v_and_b32 v187, 7, v2
    v_mul_u32_u24 v187, 4096, v187
    v_bfe_u32 v188, v2, 3, 1
    v_lshl_add_u32 v188, v6, 1, v188
    v_lshl_add_u32 v187, v188, 4, v187
    v_and_b32 v191, 1, v2
    v_mul_u32_u24 v191, 1041, v191
    v_bfe_u32 v189, v2, 1, 2
    v_mul_u32_u24 v189, 260, v189
    v_add_u32 v189, v189, v191
    v_lshlrev_b32 v190, 4, v189
    v_add_u32 v191, 37248, v4
    v_cmp_gt_u32 vcc, 8, v2
    s_nop 1
    v_cndmask_b32 v190, v191, v190, vcc
    v_mov_b32 v192, 0
    v_mov_b32 v193, 0
    v_mov_b32 v194, 0
    v_mov_b32 v195, 0
    v_cmp_gt_u32 vcc, 38, v2
    s_nop 0
    s_and_saveexec_b64 s[50:51], vcc
    ds_write_b128 v190, v[192:195]
    ds_write_b128 v190, v[192:195] offset:37888
    s_mov_b64 exec, s[50:51]
    v_add_u32 v196, 37888, v3
    v_add_u32 v197, 75776, v3
    s_waitcnt vmcnt(34)
    v_lshlrev_b32 v210, 16, v200
    v_and_b32 v211, 0xffff0000, v200
    s_waitcnt vmcnt(33)
    v_lshlrev_b32 v212, 16, v201
    v_and_b32 v213, 0xffff0000, v201
    v_pk_add_f32 v[228:229], v[210:211], v[212:213]
    s_waitcnt vmcnt(32)
    v_lshlrev_b32 v214, 16, v202
    v_and_b32 v215, 0xffff0000, v202
    v_pk_add_f32 v[228:229], v[228:229], v[214:215]
    s_waitcnt vmcnt(31)
    v_lshlrev_b32 v216, 16, v203
    v_and_b32 v217, 0xffff0000, v203
    v_pk_add_f32 v[228:229], v[228:229], v[216:217]
    s_waitcnt vmcnt(30)
    v_lshlrev_b32 v218, 16, v204
    v_and_b32 v219, 0xffff0000, v204
    v_pk_add_f32 v[228:229], v[228:229], v[218:219]
    s_waitcnt vmcnt(29)
    v_lshlrev_b32 v220, 16, v205
    v_and_b32 v221, 0xffff0000, v205
    v_pk_add_f32 v[228:229], v[228:229], v[220:221]
    s_waitcnt vmcnt(28)
    v_lshlrev_b32 v222, 16, v206
    v_and_b32 v223, 0xffff0000, v206
    v_pk_add_f32 v[228:229], v[228:229], v[222:223]
    s_waitcnt vmcnt(27)
    v_lshlrev_b32 v224, 16, v207
    v_and_b32 v225, 0xffff0000, v207
    v_pk_add_f32 v[228:229], v[228:229], v[224:225]
    s_waitcnt vmcnt(26)
    v_lshlrev_b32 v226, 16, v208
    v_and_b32 v227, 0xffff0000, v208
    v_pk_add_f32 v[228:229], v[228:229], v[226:227]
    s_cmp_lg_u32 s2, 0
    s_cbranch_scc1 sequential_preLN__ssm_conv_h3__dense_activation_relu__prompt_kernel_skip7
    v_mov_b32 v198, 1
    s_lshl_b32 s7, s5, 2
    s_mov_b64 exec, 1
    buffer_store_dword v198, off, s[72:75], s7 sc1
    s_mov_b64 exec, -1
sequential_preLN__ssm_conv_h3__dense_activation_relu__prompt_kernel_skip7:
    v_add_f32 v228, v228, v229
    s_nop 1
    v_add_f32_dpp v228, v228, v228 row_ror:8 row_mask:0xf bank_mask:0xf
    s_nop 1
    v_add_f32_dpp v228, v228, v228 row_ror:4 row_mask:0xf bank_mask:0xf
    s_nop 1
    v_add_f32_dpp v228, v228, v228 row_ror:2 row_mask:0xf bank_mask:0xf
    s_nop 1
    v_add_f32_dpp v228, v228, v228 row_ror:1 row_mask:0xf bank_mask:0xf
    v_mov_b32 v230, v228
    s_nop 1
    v_permlane16_swap_b32 v230, v228
    v_add_f32 v228, v228, v230
    v_mul_f32 v228, 0x3ae38e39, v228
    v_mov_b32 v229, v228
    v_pk_add_f32 v[210:211], v[210:211], v[228:229] neg_lo:[0,1] neg_hi:[0,1]
    v_pk_mul_f32 v[230:231], v[210:211], v[210:211]
    v_pk_add_f32 v[212:213], v[212:213], v[228:229] neg_lo:[0,1] neg_hi:[0,1]
    v_pk_fma_f32 v[230:231], v[212:213], v[212:213], v[230:231]
    v_pk_add_f32 v[214:215], v[214:215], v[228:229] neg_lo:[0,1] neg_hi:[0,1]
    v_pk_fma_f32 v[230:231], v[214:215], v[214:215], v[230:231]
    v_pk_add_f32 v[216:217], v[216:217], v[228:229] neg_lo:[0,1] neg_hi:[0,1]
    v_pk_fma_f32 v[230:231], v[216:217], v[216:217], v[230:231]
    v_pk_add_f32 v[218:219], v[218:219], v[228:229] neg_lo:[0,1] neg_hi:[0,1]
    v_pk_fma_f32 v[230:231], v[218:219], v[218:219], v[230:231]
    v_pk_add_f32 v[220:221], v[220:221], v[228:229] neg_lo:[0,1] neg_hi:[0,1]
    v_pk_fma_f32 v[230:231], v[220:221], v[220:221], v[230:231]
    v_pk_add_f32 v[222:223], v[222:223], v[228:229] neg_lo:[0,1] neg_hi:[0,1]
    v_pk_fma_f32 v[230:231], v[222:223], v[222:223], v[230:231]
    v_pk_add_f32 v[224:225], v[224:225], v[228:229] neg_lo:[0,1] neg_hi:[0,1]
    v_pk_fma_f32 v[230:231], v[224:225], v[224:225], v[230:231]
    v_pk_add_f32 v[226:227], v[226:227], v[228:229] neg_lo:[0,1] neg_hi:[0,1]
    v_pk_fma_f32 v[230:231], v[226:227], v[226:227], v[230:231]
    v_add_f32 v229, v230, v231
    s_nop 1
    v_add_f32_dpp v229, v229, v229 row_ror:8 row_mask:0xf bank_mask:0xf
    s_nop 1
    v_add_f32_dpp v229, v229, v229 row_ror:4 row_mask:0xf bank_mask:0xf
    s_nop 1
    v_add_f32_dpp v229, v229, v229 row_ror:2 row_mask:0xf bank_mask:0xf
    s_nop 1
    v_add_f32_dpp v229, v229, v229 row_ror:1 row_mask:0xf bank_mask:0xf
    v_mov_b32 v230, v229
    s_nop 1
    v_permlane16_swap_b32 v230, v229
    v_add_f32 v229, v229, v230
    v_mul_f32 v229, 0x3ae38e39, v229
    v_cvt_pk_bf16_f32 v230, v228, v229
    v_lshlrev_b32 v228, 16, v230
    v_and_b32 v229, 0xffff0000, v230
    v_add_f32 v229, 0x3727c5ac, v229
    v_cvt_pk_bf16_f32 v230, v229, v229
    v_and_b32 v229, 0xffff0000, v230
    v_sqrt_f32 v229, v229
    s_nop 0
    v_cvt_pk_bf16_f32 v230, v229, v229
    v_and_b32 v229, 0xffff0000, v230
    v_rcp_f32 v229, v229
    v_cmp_eq_u32 vcc, 1, v171
    s_nop 1
    v_cndmask_b32 v228, v228, v229, vcc
    v_lshlrev_b32 v169, 2, v169
    v_lshl_add_u32 v169, v171, 13, v169
    v_cmp_gt_u32 vcc, 2, v171
    s_mov_b32 s7, 10223616
    s_and_saveexec_b64 s[50:51], vcc
    buffer_store_dword v228, v169, s[64:67], s7 offen sc1
    s_mov_b64 exec, s[50:51]
    s_waitcnt vmcnt(23)
    v_lshlrev_b32 v60, 16, v44
    v_and_b32 v68, 0xffff0000, v44
    v_lshlrev_b32 v76, 16, v45
    v_and_b32 v84, 0xffff0000, v45
    v_lshlrev_b32 v61, 16, v46
    v_and_b32 v69, 0xffff0000, v46
    v_lshlrev_b32 v77, 16, v47
    v_and_b32 v85, 0xffff0000, v47
    v_lshlrev_b32 v62, 16, v48
    v_and_b32 v70, 0xffff0000, v48
    v_lshlrev_b32 v78, 16, v49
    v_and_b32 v86, 0xffff0000, v49
    v_lshlrev_b32 v63, 16, v50
    v_and_b32 v71, 0xffff0000, v50
    v_lshlrev_b32 v79, 16, v51
    v_and_b32 v87, 0xffff0000, v51
    v_lshlrev_b32 v64, 16, v52
    v_and_b32 v72, 0xffff0000, v52
    v_lshlrev_b32 v80, 16, v53
    v_and_b32 v88, 0xffff0000, v53
    v_lshlrev_b32 v65, 16, v54
    v_and_b32 v73, 0xffff0000, v54
    v_lshlrev_b32 v81, 16, v55
    v_and_b32 v89, 0xffff0000, v55
    v_lshlrev_b32 v66, 16, v56
    v_and_b32 v74, 0xffff0000, v56
    v_lshlrev_b32 v82, 16, v57
    v_and_b32 v90, 0xffff0000, v57
    v_lshlrev_b32 v67, 16, v58
    v_and_b32 v75, 0xffff0000, v58
    v_lshlrev_b32 v83, 16, v59
    v_and_b32 v91, 0xffff0000, v59
    s_waitcnt vmcnt(18)
    v_lshlrev_b32 v92, 16, v8
    v_and_b32 v93, 0xffff0000, v8
    v_lshlrev_b32 v94, 16, v9
    v_and_b32 v95, 0xffff0000, v9
    v_lshlrev_b32 v96, 16, v10
    v_and_b32 v97, 0xffff0000, v10
    v_lshlrev_b32 v98, 16, v11
    v_and_b32 v99, 0xffff0000, v11
    v_lshlrev_b32 v100, 16, v12
    v_and_b32 v101, 0xffff0000, v12
    v_lshlrev_b32 v102, 16, v13
    v_and_b32 v103, 0xffff0000, v13
    v_lshlrev_b32 v104, 16, v14
    v_and_b32 v105, 0xffff0000, v14
    v_lshlrev_b32 v106, 16, v15
    v_and_b32 v107, 0xffff0000, v15
    v_lshlrev_b32 v108, 16, v16
    v_and_b32 v109, 0xffff0000, v16
    v_lshlrev_b32 v110, 16, v17
    v_and_b32 v111, 0xffff0000, v17
    v_lshlrev_b32 v112, 16, v18
    v_and_b32 v113, 0xffff0000, v18
    v_lshlrev_b32 v114, 16, v19
    v_and_b32 v115, 0xffff0000, v19
    v_lshlrev_b32 v116, 16, v20
    v_and_b32 v117, 0xffff0000, v20
    v_lshlrev_b32 v118, 16, v21
    v_and_b32 v119, 0xffff0000, v21
    v_lshlrev_b32 v120, 16, v22
    v_and_b32 v121, 0xffff0000, v22
    v_lshlrev_b32 v122, 16, v23
    v_and_b32 v123, 0xffff0000, v23
    v_lshlrev_b32 v124, 16, v24
    v_and_b32 v125, 0xffff0000, v24
    v_lshlrev_b32 v126, 16, v25
    v_and_b32 v127, 0xffff0000, v25
    v_lshlrev_b32 v128, 16, v26
    v_and_b32 v129, 0xffff0000, v26
    v_lshlrev_b32 v130, 16, v27
    v_and_b32 v131, 0xffff0000, v27
    s_waitcnt vmcnt(7)
    ds_write_b128 v182, v[36:39]
    ds_write_b128 v182, v[40:43] offset:128
    v_lshlrev_b32 v132, 16, v28
    v_and_b32 v133, 0xffff0000, v28
    v_lshlrev_b32 v134, 16, v29
    v_and_b32 v135, 0xffff0000, v29
    v_lshlrev_b32 v136, 16, v30
    v_and_b32 v137, 0xffff0000, v30
    v_lshlrev_b32 v138, 16, v31
    v_and_b32 v139, 0xffff0000, v31
    v_lshlrev_b32 v140, 16, v32
    v_and_b32 v141, 0xffff0000, v32
    v_lshlrev_b32 v142, 16, v33
    v_and_b32 v143, 0xffff0000, v33
    v_lshlrev_b32 v144, 16, v34
    v_and_b32 v145, 0xffff0000, v34
    v_lshlrev_b32 v146, 16, v35
    v_and_b32 v147, 0xffff0000, v35
    v_pk_mul_f32 v[148:149], v[92:93], v[84:85]
    v_cvt_pk_bf16_f32 v152, v148, v149
    v_lshlrev_b32 v148, 16, v152
    v_and_b32 v149, 0xffff0000, v152
    v_pk_mul_f32 v[150:151], v[100:101], v[76:77]
    v_cvt_pk_bf16_f32 v152, v150, v151
    v_lshlrev_b32 v150, 16, v152
    v_and_b32 v151, 0xffff0000, v152
    v_pk_add_f32 v[148:149], v[148:149], v[150:151]
    v_cvt_pk_bf16_f32 v152, v148, v149
    v_lshlrev_b32 v148, 16, v152
    v_and_b32 v149, 0xffff0000, v152
    v_pk_mul_f32 v[150:151], v[108:109], v[68:69]
    v_cvt_pk_bf16_f32 v152, v150, v151
    v_lshlrev_b32 v150, 16, v152
    v_and_b32 v151, 0xffff0000, v152
    v_pk_add_f32 v[148:149], v[148:149], v[150:151]
    v_cvt_pk_bf16_f32 v152, v148, v149
    v_lshlrev_b32 v148, 16, v152
    v_and_b32 v149, 0xffff0000, v152
    v_pk_mul_f32 v[150:151], v[116:117], v[60:61]
    v_cvt_pk_bf16_f32 v152, v150, v151
    v_lshlrev_b32 v150, 16, v152
    v_and_b32 v151, 0xffff0000, v152
    v_pk_add_f32 v[148:149], v[148:149], v[150:151]
    v_cvt_pk_bf16_f32 v152, v148, v149
    v_lshlrev_b32 v148, 16, v152
    v_and_b32 v149, 0xffff0000, v152
    v_pk_mul_f32 v[148:149], v[148:149], v[132:133]
    v_cvt_pk_bf16_f32 v156, v148, v149
    v_pk_mul_f32 v[148:149], v[94:95], v[86:87]
    v_cvt_pk_bf16_f32 v152, v148, v149
    v_lshlrev_b32 v148, 16, v152
    v_and_b32 v149, 0xffff0000, v152
    v_pk_mul_f32 v[150:151], v[102:103], v[78:79]
    v_cvt_pk_bf16_f32 v152, v150, v151
    v_lshlrev_b32 v150, 16, v152
    v_and_b32 v151, 0xffff0000, v152
    v_pk_add_f32 v[148:149], v[148:149], v[150:151]
    v_cvt_pk_bf16_f32 v152, v148, v149
    v_lshlrev_b32 v148, 16, v152
    v_and_b32 v149, 0xffff0000, v152
    v_pk_mul_f32 v[150:151], v[110:111], v[70:71]
    v_cvt_pk_bf16_f32 v152, v150, v151
    v_lshlrev_b32 v150, 16, v152
    v_and_b32 v151, 0xffff0000, v152
    v_pk_add_f32 v[148:149], v[148:149], v[150:151]
    v_cvt_pk_bf16_f32 v152, v148, v149
    v_lshlrev_b32 v148, 16, v152
    v_and_b32 v149, 0xffff0000, v152
    v_pk_mul_f32 v[150:151], v[118:119], v[62:63]
    v_cvt_pk_bf16_f32 v152, v150, v151
    v_lshlrev_b32 v150, 16, v152
    v_and_b32 v151, 0xffff0000, v152
    v_pk_add_f32 v[148:149], v[148:149], v[150:151]
    v_cvt_pk_bf16_f32 v152, v148, v149
    v_lshlrev_b32 v148, 16, v152
    v_and_b32 v149, 0xffff0000, v152
    v_pk_mul_f32 v[148:149], v[148:149], v[134:135]
    v_cvt_pk_bf16_f32 v157, v148, v149
    v_pk_mul_f32 v[148:149], v[96:97], v[88:89]
    v_cvt_pk_bf16_f32 v152, v148, v149
    v_lshlrev_b32 v148, 16, v152
    v_and_b32 v149, 0xffff0000, v152
    v_pk_mul_f32 v[150:151], v[104:105], v[80:81]
    v_cvt_pk_bf16_f32 v152, v150, v151
    v_lshlrev_b32 v150, 16, v152
    v_and_b32 v151, 0xffff0000, v152
    v_pk_add_f32 v[148:149], v[148:149], v[150:151]
    v_cvt_pk_bf16_f32 v152, v148, v149
    v_lshlrev_b32 v148, 16, v152
    v_and_b32 v149, 0xffff0000, v152
    v_pk_mul_f32 v[150:151], v[112:113], v[72:73]
    v_cvt_pk_bf16_f32 v152, v150, v151
    v_lshlrev_b32 v150, 16, v152
    v_and_b32 v151, 0xffff0000, v152
    v_pk_add_f32 v[148:149], v[148:149], v[150:151]
    v_cvt_pk_bf16_f32 v152, v148, v149
    v_lshlrev_b32 v148, 16, v152
    v_and_b32 v149, 0xffff0000, v152
    v_pk_mul_f32 v[150:151], v[120:121], v[64:65]
    v_cvt_pk_bf16_f32 v152, v150, v151
    v_lshlrev_b32 v150, 16, v152
    v_and_b32 v151, 0xffff0000, v152
    v_pk_add_f32 v[148:149], v[148:149], v[150:151]
    v_cvt_pk_bf16_f32 v152, v148, v149
    v_lshlrev_b32 v148, 16, v152
    v_and_b32 v149, 0xffff0000, v152
    v_pk_mul_f32 v[148:149], v[148:149], v[136:137]
    v_cvt_pk_bf16_f32 v158, v148, v149
    v_pk_mul_f32 v[148:149], v[98:99], v[90:91]
    v_cvt_pk_bf16_f32 v152, v148, v149
    v_lshlrev_b32 v148, 16, v152
    v_and_b32 v149, 0xffff0000, v152
    v_pk_mul_f32 v[150:151], v[106:107], v[82:83]
    v_cvt_pk_bf16_f32 v152, v150, v151
    v_lshlrev_b32 v150, 16, v152
    v_and_b32 v151, 0xffff0000, v152
    v_pk_add_f32 v[148:149], v[148:149], v[150:151]
    v_cvt_pk_bf16_f32 v152, v148, v149
    v_lshlrev_b32 v148, 16, v152
    v_and_b32 v149, 0xffff0000, v152
    v_pk_mul_f32 v[150:151], v[114:115], v[74:75]
    v_cvt_pk_bf16_f32 v152, v150, v151
    v_lshlrev_b32 v150, 16, v152
    v_and_b32 v151, 0xffff0000, v152
    v_pk_add_f32 v[148:149], v[148:149], v[150:151]
    v_cvt_pk_bf16_f32 v152, v148, v149
    v_lshlrev_b32 v148, 16, v152
    v_and_b32 v149, 0xffff0000, v152
    v_pk_mul_f32 v[150:151], v[122:123], v[66:67]
    v_cvt_pk_bf16_f32 v152, v150, v151
    v_lshlrev_b32 v150, 16, v152
    v_and_b32 v151, 0xffff0000, v152
    v_pk_add_f32 v[148:149], v[148:149], v[150:151]
    v_cvt_pk_bf16_f32 v152, v148, v149
    v_lshlrev_b32 v148, 16, v152
    v_and_b32 v149, 0xffff0000, v152
    v_pk_mul_f32 v[148:149], v[148:149], v[138:139]
    v_cvt_pk_bf16_f32 v159, v148, v149
    ds_write_b128 v183, v[156:159] offset:128
    v_pk_mul_f32 v[148:149], v[100:101], v[84:85]
    v_cvt_pk_bf16_f32 v152, v148, v149
    v_lshlrev_b32 v148, 16, v152
    v_and_b32 v149, 0xffff0000, v152
    v_pk_mul_f32 v[150:151], v[108:109], v[76:77]
    v_cvt_pk_bf16_f32 v152, v150, v151
    v_lshlrev_b32 v150, 16, v152
    v_and_b32 v151, 0xffff0000, v152
    v_pk_add_f32 v[148:149], v[148:149], v[150:151]
    v_cvt_pk_bf16_f32 v152, v148, v149
    v_lshlrev_b32 v148, 16, v152
    v_and_b32 v149, 0xffff0000, v152
    v_pk_mul_f32 v[150:151], v[116:117], v[68:69]
    v_cvt_pk_bf16_f32 v152, v150, v151
    v_lshlrev_b32 v150, 16, v152
    v_and_b32 v151, 0xffff0000, v152
    v_pk_add_f32 v[148:149], v[148:149], v[150:151]
    v_cvt_pk_bf16_f32 v152, v148, v149
    v_lshlrev_b32 v148, 16, v152
    v_and_b32 v149, 0xffff0000, v152
    v_pk_mul_f32 v[150:151], v[124:125], v[60:61]
    v_cvt_pk_bf16_f32 v152, v150, v151
    v_lshlrev_b32 v150, 16, v152
    v_and_b32 v151, 0xffff0000, v152
    v_pk_add_f32 v[148:149], v[148:149], v[150:151]
    v_cvt_pk_bf16_f32 v152, v148, v149
    v_lshlrev_b32 v148, 16, v152
    v_and_b32 v149, 0xffff0000, v152
    v_pk_mul_f32 v[148:149], v[148:149], v[140:141]
    v_cvt_pk_bf16_f32 v160, v148, v149
    v_pk_mul_f32 v[148:149], v[102:103], v[86:87]
    v_cvt_pk_bf16_f32 v152, v148, v149
    v_lshlrev_b32 v148, 16, v152
    v_and_b32 v149, 0xffff0000, v152
    v_pk_mul_f32 v[150:151], v[110:111], v[78:79]
    v_cvt_pk_bf16_f32 v152, v150, v151
    v_lshlrev_b32 v150, 16, v152
    v_and_b32 v151, 0xffff0000, v152
    v_pk_add_f32 v[148:149], v[148:149], v[150:151]
    v_cvt_pk_bf16_f32 v152, v148, v149
    v_lshlrev_b32 v148, 16, v152
    v_and_b32 v149, 0xffff0000, v152
    v_pk_mul_f32 v[150:151], v[118:119], v[70:71]
    v_cvt_pk_bf16_f32 v152, v150, v151
    v_lshlrev_b32 v150, 16, v152
    v_and_b32 v151, 0xffff0000, v152
    v_pk_add_f32 v[148:149], v[148:149], v[150:151]
    v_cvt_pk_bf16_f32 v152, v148, v149
    v_lshlrev_b32 v148, 16, v152
    v_and_b32 v149, 0xffff0000, v152
    v_pk_mul_f32 v[150:151], v[126:127], v[62:63]
    v_cvt_pk_bf16_f32 v152, v150, v151
    v_lshlrev_b32 v150, 16, v152
    v_and_b32 v151, 0xffff0000, v152
    v_pk_add_f32 v[148:149], v[148:149], v[150:151]
    v_cvt_pk_bf16_f32 v152, v148, v149
    v_lshlrev_b32 v148, 16, v152
    v_and_b32 v149, 0xffff0000, v152
    v_pk_mul_f32 v[148:149], v[148:149], v[142:143]
    v_cvt_pk_bf16_f32 v161, v148, v149
    v_pk_mul_f32 v[148:149], v[104:105], v[88:89]
    v_cvt_pk_bf16_f32 v152, v148, v149
    v_lshlrev_b32 v148, 16, v152
    v_and_b32 v149, 0xffff0000, v152
    v_pk_mul_f32 v[150:151], v[112:113], v[80:81]
    v_cvt_pk_bf16_f32 v152, v150, v151
    v_lshlrev_b32 v150, 16, v152
    v_and_b32 v151, 0xffff0000, v152
    v_pk_add_f32 v[148:149], v[148:149], v[150:151]
    v_cvt_pk_bf16_f32 v152, v148, v149
    v_lshlrev_b32 v148, 16, v152
    v_and_b32 v149, 0xffff0000, v152
    v_pk_mul_f32 v[150:151], v[120:121], v[72:73]
    v_cvt_pk_bf16_f32 v152, v150, v151
    v_lshlrev_b32 v150, 16, v152
    v_and_b32 v151, 0xffff0000, v152
    v_pk_add_f32 v[148:149], v[148:149], v[150:151]
    v_cvt_pk_bf16_f32 v152, v148, v149
    v_lshlrev_b32 v148, 16, v152
    v_and_b32 v149, 0xffff0000, v152
    v_pk_mul_f32 v[150:151], v[128:129], v[64:65]
    v_cvt_pk_bf16_f32 v152, v150, v151
    v_lshlrev_b32 v150, 16, v152
    v_and_b32 v151, 0xffff0000, v152
    v_pk_add_f32 v[148:149], v[148:149], v[150:151]
    v_cvt_pk_bf16_f32 v152, v148, v149
    v_lshlrev_b32 v148, 16, v152
    v_and_b32 v149, 0xffff0000, v152
    v_pk_mul_f32 v[148:149], v[148:149], v[144:145]
    v_cvt_pk_bf16_f32 v162, v148, v149
    v_pk_mul_f32 v[148:149], v[106:107], v[90:91]
    v_cvt_pk_bf16_f32 v152, v148, v149
    v_lshlrev_b32 v148, 16, v152
    v_and_b32 v149, 0xffff0000, v152
    v_pk_mul_f32 v[150:151], v[114:115], v[82:83]
    v_cvt_pk_bf16_f32 v152, v150, v151
    v_lshlrev_b32 v150, 16, v152
    v_and_b32 v151, 0xffff0000, v152
    v_pk_add_f32 v[148:149], v[148:149], v[150:151]
    v_cvt_pk_bf16_f32 v152, v148, v149
    v_lshlrev_b32 v148, 16, v152
    v_and_b32 v149, 0xffff0000, v152
    v_pk_mul_f32 v[150:151], v[122:123], v[74:75]
    v_cvt_pk_bf16_f32 v152, v150, v151
    v_lshlrev_b32 v150, 16, v152
    v_and_b32 v151, 0xffff0000, v152
    v_pk_add_f32 v[148:149], v[148:149], v[150:151]
    v_cvt_pk_bf16_f32 v152, v148, v149
    v_lshlrev_b32 v148, 16, v152
    v_and_b32 v149, 0xffff0000, v152
    v_pk_mul_f32 v[150:151], v[130:131], v[66:67]
    v_cvt_pk_bf16_f32 v152, v150, v151
    v_lshlrev_b32 v150, 16, v152
    v_and_b32 v151, 0xffff0000, v152
    v_pk_add_f32 v[148:149], v[148:149], v[150:151]
    v_cvt_pk_bf16_f32 v152, v148, v149
    v_lshlrev_b32 v148, 16, v152
    v_and_b32 v149, 0xffff0000, v152
    v_pk_mul_f32 v[148:149], v[148:149], v[146:147]
    v_cvt_pk_bf16_f32 v163, v148, v149
    ds_write_b128 v183, v[160:163] offset:0
    v_accvgpr_read_b32 v8, a20
    v_accvgpr_read_b32 v9, a21
    v_accvgpr_read_b32 v10, a22
    v_accvgpr_read_b32 v11, a23
    v_accvgpr_read_b32 v12, a24
    v_accvgpr_read_b32 v13, a25
    v_accvgpr_read_b32 v14, a26
    v_accvgpr_read_b32 v15, a27
    v_accvgpr_read_b32 v16, a28
    v_accvgpr_read_b32 v17, a29
    v_lshlrev_b32 v60, 16, v8
    v_and_b32 v62, 0xffff0000, v8
    v_lshlrev_b32 v64, 16, v9
    v_and_b32 v66, 0xffff0000, v9
    v_lshlrev_b32 v61, 16, v10
    v_and_b32 v63, 0xffff0000, v10
    v_lshlrev_b32 v65, 16, v11
    v_and_b32 v67, 0xffff0000, v11
    v_lshlrev_b32 v92, 16, v12
    v_and_b32 v93, 0xffff0000, v12
    v_lshlrev_b32 v94, 16, v13
    v_and_b32 v95, 0xffff0000, v13
    v_lshlrev_b32 v96, 16, v14
    v_and_b32 v97, 0xffff0000, v14
    v_lshlrev_b32 v98, 16, v15
    v_and_b32 v99, 0xffff0000, v15
    v_lshlrev_b32 v132, 16, v16
    v_and_b32 v133, 0xffff0000, v16
    ds_write_b32 v176, v17
    v_pk_mul_f32 v[148:149], v[92:93], v[66:67]
    v_cvt_pk_bf16_f32 v152, v148, v149
    v_lshlrev_b32 v148, 16, v152
    v_and_b32 v149, 0xffff0000, v152
    v_pk_mul_f32 v[150:151], v[94:95], v[64:65]
    v_cvt_pk_bf16_f32 v152, v150, v151
    v_lshlrev_b32 v150, 16, v152
    v_and_b32 v151, 0xffff0000, v152
    v_pk_add_f32 v[148:149], v[148:149], v[150:151]
    v_cvt_pk_bf16_f32 v152, v148, v149
    v_lshlrev_b32 v148, 16, v152
    v_and_b32 v149, 0xffff0000, v152
    v_pk_mul_f32 v[150:151], v[96:97], v[62:63]
    v_cvt_pk_bf16_f32 v152, v150, v151
    v_lshlrev_b32 v150, 16, v152
    v_and_b32 v151, 0xffff0000, v152
    v_pk_add_f32 v[148:149], v[148:149], v[150:151]
    v_cvt_pk_bf16_f32 v152, v148, v149
    v_lshlrev_b32 v148, 16, v152
    v_and_b32 v149, 0xffff0000, v152
    v_pk_mul_f32 v[150:151], v[98:99], v[60:61]
    v_cvt_pk_bf16_f32 v152, v150, v151
    v_lshlrev_b32 v150, 16, v152
    v_and_b32 v151, 0xffff0000, v152
    v_pk_add_f32 v[148:149], v[148:149], v[150:151]
    v_cvt_pk_bf16_f32 v152, v148, v149
    v_lshlrev_b32 v148, 16, v152
    v_and_b32 v149, 0xffff0000, v152
    v_pk_mul_f32 v[148:149], v[148:149], v[132:133]
    v_cvt_pk_bf16_f32 v156, v148, v149
    ds_write_b32 v175, v156
    s_waitcnt lgkmcnt(0)
    s_barrier
    s_cmp_ge_u32 s5, 2
    s_cbranch_scc1 sequential_preLN__ssm_conv_h3__dense_activation_relu__prompt_kernel_skip8
    s_mul_i32 s6, s4, 294912
    s_mul_i32 s7, s5, 131072
    s_add_u32 s6, s6, s7
    s_lshl_b32 s7, s3, 7
    s_add_u32 s50, s6, 2621440
    s_add_u32 s50, s50, s7
    s_add_u32 s51, s6, 3968
    s_sub_u32 s51, s51, s7
    s_lshl_b32 s7, s5, 2
    s_add_u32 s6, s7, 0
    v_xor_b32 v188, s6, v184
    v_lshl_add_u32 v188, v188, 4, v186
    ds_read_b64_tr_b16 v[60:61], v188 offset:0
    ds_read_b64_tr_b16 v[62:63], v188 offset:512
    ds_read_b64_tr_b16 v[64:65], v188 offset:8192
    ds_read_b64_tr_b16 v[66:67], v188 offset:8704
    s_add_u32 s6, s7, 1
    v_xor_b32 v188, s6, v184
    v_lshl_add_u32 v188, v188, 4, v186
    ds_read_b64_tr_b16 v[68:69], v188 offset:0
    ds_read_b64_tr_b16 v[70:71], v188 offset:512
    ds_read_b64_tr_b16 v[72:73], v188 offset:8192
    ds_read_b64_tr_b16 v[74:75], v188 offset:8704
    s_add_u32 s6, s7, 2
    v_xor_b32 v188, s6, v184
    v_lshl_add_u32 v188, v188, 4, v186
    ds_read_b64_tr_b16 v[76:77], v188 offset:0
    ds_read_b64_tr_b16 v[78:79], v188 offset:512
    ds_read_b64_tr_b16 v[80:81], v188 offset:8192
    ds_read_b64_tr_b16 v[82:83], v188 offset:8704
    s_add_u32 s6, s7, 3
    v_xor_b32 v188, s6, v184
    v_lshl_add_u32 v188, v188, 4, v186
    ds_read_b64_tr_b16 v[84:85], v188 offset:0
    ds_read_b64_tr_b16 v[86:87], v188 offset:512
    ds_read_b64_tr_b16 v[88:89], v188 offset:8192
    ds_read_b64_tr_b16 v[90:91], v188 offset:8704
    ds_read_b64_tr_b16 v[92:93], v177 offset:0
    ds_read_b64_tr_b16 v[94:95], v177 offset:64
    s_add_u32 s6, s51, 262144
    s_add_u32 s7, s50, 131072
    s_cmp_eq_u32 s5, 0
    s_cselect_b32 s6, s6, s7
    s_waitcnt lgkmcnt(15)
    buffer_store_dwordx4 v[60:63], v187, s[64:67], s51 offen sc1
    s_waitcnt lgkmcnt(14)
    buffer_store_dwordx4 v[64:67], v187, s[64:67], s50 offen sc1
    s_add_u32 s50, s50, 32768
    s_add_u32 s51, s51, 32768
    s_waitcnt lgkmcnt(12)
    buffer_store_dwordx4 v[68:71], v187, s[64:67], s51 offen sc1
    s_waitcnt lgkmcnt(10)
    buffer_store_dwordx4 v[72:75], v187, s[64:67], s50 offen sc1
    s_add_u32 s50, s50, 32768
    s_add_u32 s51, s51, 32768
    s_waitcnt lgkmcnt(8)
    buffer_store_dwordx4 v[76:79], v187, s[64:67], s51 offen sc1
    s_waitcnt lgkmcnt(6)
    buffer_store_dwordx4 v[80:83], v187, s[64:67], s50 offen sc1
    s_add_u32 s50, s50, 32768
    s_add_u32 s51, s51, 32768
    s_waitcnt lgkmcnt(4)
    buffer_store_dwordx4 v[84:87], v187, s[64:67], s51 offen sc1
    s_waitcnt lgkmcnt(2)
    buffer_store_dwordx4 v[88:91], v187, s[64:67], s50 offen sc1
    s_waitcnt lgkmcnt(0)
    buffer_store_dwordx4 v[92:95], v187, s[64:67], s6 offen sc1
sequential_preLN__ssm_conv_h3__dense_activation_relu__prompt_kernel_skip8:
    s_and_b32 s7, s2, 3
    s_lshl_b32 s7, s7, 7
    v_lshlrev_b32 v198, 9, v2
    v_add_u32 v198, s7, v198
    s_bfe_u32 s7, s2, 0x40002
    s_lshl_b32 s7, s7, 9
    v_and_b32 v199, 3, v2
    v_lshlrev_b32 v164, 2, v199
    v_lshlrev_b32 v199, 7, v199
    v_add_u32 v199, s7, v199
    v_mov_b32 v163, 1
    s_cmp_ge_u32 s5, 2
    s_cbranch_scc1 sequential_preLN__ssm_conv_h3__dense_activation_relu__prompt_kernel_skip9
    buffer_load_dword v162, v164, s[72:75], 0 offen sc1
    s_waitcnt vmcnt(0)
sequential_preLN__ssm_conv_h3__dense_activation_relu__prompt_kernel_skip9:
    s_waitcnt vmcnt(0)
    s_barrier
    s_cmp_lg_u32 s5, 0
    s_cbranch_scc1 sequential_preLN__ssm_conv_h3__dense_activation_relu__prompt_kernel_skip10
    s_mov_b32 s12, 400000
sequential_preLN__ssm_conv_h3__dense_activation_relu__prompt_kernel_rdy11:
    v_cmp_ne_u32 vcc, 1, v162
    s_nop 4
    s_cbranch_vccz sequential_preLN__ssm_conv_h3__dense_activation_relu__prompt_kernel_rdyok12
    s_sub_u32 s12, s12, 1
    s_cmp_eq_u32 s12, 0
    s_cbranch_scc1 sequential_preLN__ssm_conv_h3__dense_activation_relu__prompt_kernel_rdyok12
    s_sleep 1
    buffer_load_dword v162, v164, s[72:75], 0 offen sc1
    s_waitcnt vmcnt(0)
    s_branch sequential_preLN__ssm_conv_h3__dense_activation_relu__prompt_kernel_rdy11
sequential_preLN__ssm_conv_h3__dense_activation_relu__prompt_kernel_rdyok12:
    s_mov_b32 s7, 10289152
    s_mov_b64 exec, 0xffff
    buffer_atomic_add v163, v198, s[64:67], s7 offen
    s_mov_b64 exec, -1
sequential_preLN__ssm_conv_h3__dense_activation_relu__prompt_kernel_skip10:
    s_mov_b32 s82, s47
    s_mov_b32 s83, s49
    s_mov_b32 s76, s44
    s_mov_b32 s40, s30
    s_mov_b32 s41, s31
    s_mov_b32 s42, 0x510000
    s_mov_b32 s43, 0x20000
    v_mov_b32 v60, v233
    v_mov_b32 v61, v234
    v_mov_b32 v62, v235
    v_mov_b32 v63, v236
    v_mov_b32 v64, v237
    v_mov_b32 v65, v238
    v_alignbit_b32 v68, v233, v232, 16
    v_alignbit_b32 v69, v234, v233, 16
    v_alignbit_b32 v70, v235, v234, 16
    v_alignbit_b32 v71, v236, v235, 16
    v_alignbit_b32 v72, v237, v236, 16
    v_alignbit_b32 v73, v238, v237, 16
    v_alignbit_b32 v74, v239, v238, 16
    v_alignbit_b32 v76, v234, v233, 16
    v_alignbit_b32 v77, v235, v234, 16
    v_alignbit_b32 v78, v236, v235, 16
    v_alignbit_b32 v79, v237, v236, 16
    v_alignbit_b32 v80, v238, v237, 16
    v_alignbit_b32 v81, v239, v238, 16
    ds_write_b128 v3, v[68:71] offset:16
    ds_write_b128 v3, v[60:63] offset:16672
    ds_write_b128 v3, v[76:79] offset:4176
    ds_write_b128 v3, v[234:237] offset:20832
    ds_write_b128 v3, v[70:73] offset:8336
    ds_write_b128 v3, v[62:65] offset:24992
    ds_write_b128 v3, v[78:81] offset:12496
    ds_write_b128 v3, v[236:239] offset:29152
    v_mov_b32 v60, v241
    v_mov_b32 v61, v242
    v_mov_b32 v62, v243
    v_mov_b32 v63, v244
    v_mov_b32 v64, v245
    v_mov_b32 v65, v246
    v_alignbit_b32 v68, v241, v240, 16
    v_alignbit_b32 v69, v242, v241, 16
    v_alignbit_b32 v70, v243, v242, 16
    v_alignbit_b32 v71, v244, v243, 16
    v_alignbit_b32 v72, v245, v244, 16
    v_alignbit_b32 v73, v246, v245, 16
    v_alignbit_b32 v74, v247, v246, 16
    v_alignbit_b32 v76, v242, v241, 16
    v_alignbit_b32 v77, v243, v242, 16
    v_alignbit_b32 v78, v244, v243, 16
    v_alignbit_b32 v79, v245, v244, 16
    v_alignbit_b32 v80, v246, v245, 16
    v_alignbit_b32 v81, v247, v246, 16
    ds_write_b128 v196, v[68:71] offset:16
    ds_write_b128 v196, v[60:63] offset:16672
    ds_write_b128 v196, v[76:79] offset:4176
    ds_write_b128 v196, v[242:245] offset:20832
    ds_write_b128 v196, v[70:73] offset:8336
    ds_write_b128 v196, v[62:65] offset:24992
    ds_write_b128 v196, v[78:81] offset:12496
    ds_write_b128 v196, v[244:247] offset:29152
    s_cmp_ge_u32 s2, 64
    s_cbranch_scc1 sequential_preLN__ssm_conv_h3__dense_activation_relu__prompt_kernel_skip13
    v_mov_b32 v60, v249
    v_mov_b32 v61, v250
    v_mov_b32 v62, v251
    v_mov_b32 v63, v252
    v_mov_b32 v64, v253
    v_mov_b32 v65, v254
    v_alignbit_b32 v68, v249, v248, 16
    v_alignbit_b32 v69, v250, v249, 16
    v_alignbit_b32 v70, v251, v250, 16
    v_alignbit_b32 v71, v252, v251, 16
    v_alignbit_b32 v72, v253, v252, 16
    v_alignbit_b32 v73, v254, v253, 16
    v_alignbit_b32 v74, v255, v254, 16
    v_alignbit_b32 v76, v250, v249, 16
    v_alignbit_b32 v77, v251, v250, 16
    v_alignbit_b32 v78, v252, v251, 16
    v_alignbit_b32 v79, v253, v252, 16
    v_alignbit_b32 v80, v254, v253, 16
    v_alignbit_b32 v81, v255, v254, 16
    ds_write_b128 v197, v[68:71] offset:16
    ds_write_b128 v197, v[60:63] offset:16672
    ds_write_b128 v197, v[76:79] offset:4176
    ds_write_b128 v197, v[250:253] offset:20832
    ds_write_b128 v197, v[70:73] offset:8336
    ds_write_b128 v197, v[62:65] offset:24992
    ds_write_b128 v197, v[78:81] offset:12496
    ds_write_b128 v197, v[252:255] offset:29152
    v_cmp_gt_u32 vcc, 38, v2
    v_add_u32 v190, 75776, v190
    s_and_saveexec_b64 s[50:51], vcc
    ds_write_b128 v190, v[192:195]
    s_mov_b64 exec, s[50:51]
sequential_preLN__ssm_conv_h3__dense_activation_relu__prompt_kernel_skip13:
    s_waitcnt lgkmcnt(0)
    s_barrier
    v_mov_b32 v72, v198
    v_mov_b32 v73, v199
    v_mov_b32 v74, 1
    v_lshlrev_b32 v7, 5, v5
    v_lshl_add_u32 v7, v6, 3, v7
    v_lshlrev_b32 v8, 1, v7
    v_lshrrev_b32 v10, 3, v5
    v_add3_u32 v9, v189, v6, v10
    s_lshl_b32 s14, s5, 2
    v_add_u32 v9, s14, v9
    v_lshlrev_b32 v9, 4, v9
    s_lshl_b32 s14, s5, 6
    s_add_u32 s14, s14, 33760
    v_lshlrev_b32 v10, 4, v6
    v_add_u32 v10, s14, v10
    v_lshlrev_b32 v11, 5, v5
    v_sub_u32 v10, v10, v11
    s_sub_u32 s14, 36856, s8
    v_sub_u32 v11, s14, v7
    v_add_u32 v13, s8, v4
    s_lshl_b32 s14, s5, 13
    v_add_u32 v12, s14, v4
    v_add_u32 v14, 37888, v9
    v_add_u32 v248, 75776, v9
    v_add_u32 v15, 37888, v10
    v_add_u32 v249, 75776, v10
    v_add_u32 v16, 37888, v11
    v_add_u32 v250, 75776, v11
    v_add_u32 v17, 37888, v12
    v_add_u32 v251, 75776, v12
    v_add_u32 v18, 37888, v13
    v_add_u32 v252, 75776, v13
    v_lshlrev_b32 v19, 5, v5
    v_lshrrev_b32 v253, 1, v6
    v_lshl_add_u32 v19, v253, 4, v19
    v_and_b32 v253, 1, v6
    v_lshl_add_u32 v19, v253, 9, v19
    s_cmp_lt_u32 s2, 112
    s_cbranch_scc1 sequential_preLN__ssm_conv_h3__dense_activation_relu__prompt_kernel_skip14
    s_add_u32 s13, s2, 32
    s_and_b32 s14, s13, 1
    s_lshr_b32 s15, s13, 1
    s_cmp_ge_u32 s15, 72
    s_cbranch_scc1 sequential_preLN__ssm_conv_h3__dense_activation_relu__prompt_kernel_uw215
    s_mov_b32 s60, s30
    s_mov_b32 s61, s31
    s_mov_b32 s62, 0x510000
    s_mov_b32 s63, 0x20000
    s_mul_i32 s44, s14, 2654208
    s_lshl_b32 s45, s15, 7
    s_add_u32 s44, s44, s45
    s_mov_b32 s46, 9216
    s_lshl_b32 s47, s15, 2
    s_add_u32 s47, s47, s5
    s_mov_b32 s48, 1
    s_branch sequential_preLN__ssm_conv_h3__dense_activation_relu__prompt_kernel_uend16
sequential_preLN__ssm_conv_h3__dense_activation_relu__prompt_kernel_uw215:
    s_mov_b32 s60, s32
    s_mov_b32 s61, s33
    s_mov_b32 s62, 0x510000
    s_mov_b32 s63, 0x20000
    s_sub_u32 s15, s15, 72
    s_mul_i32 s45, s15, 7282
    s_lshr_b32 s45, s45, 16
    s_mul_i32 s46, s45, 9
    s_sub_u32 s46, s15, s46
    s_mul_i32 s44, s45, 663552
    s_lshl_b32 s47, s46, 7
    s_add_u32 s44, s44, s47
    s_mul_i32 s47, s14, 331776
    s_add_u32 s44, s44, s47
    s_lshl_b32 s46, s46, 1
    s_lshr_b32 s47, s5, 1
    s_add_u32 s46, s46, s47
    s_and_b32 s47, s5, 1
    s_lshr_b32 s48, s46, 2
    s_mul_i32 s48, s48, 9
    s_and_b32 s49, s46, 3
    s_lshl_b32 s49, s49, 1
    s_add_u32 s48, s48, s49
    s_add_u32 s48, s48, s47
    s_sub_u32 s49, s46, 16
    s_lshl_b32 s49, s49, 1
    s_add_u32 s49, s49, s47
    s_mul_i32 s49, s49, 9
    s_add_u32 s49, s49, 8
    s_cmp_lt_u32 s46, 16
    s_cselect_b32 s47, s48, s49
    s_mul_i32 s45, s45, 36
    s_add_u32 s47, s47, s45
    s_add_u32 s47, s47, 288
    s_mov_b32 s46, 1152
    s_mov_b32 s48, 0
sequential_preLN__ssm_conv_h3__dense_activation_relu__prompt_kernel_uend16:
    s_mul_i32 s49, s47, 18432
    s_mul_i32 s45, s14, 9216
    s_add_u32 s49, s49, s45
    s_add_u32 s49, s49, 10485760
    s_mul_i32 s45, s14, 18432
    s_lshl_b32 s47, s47, 6
    s_add_u32 s47, s47, s45
    s_add_u32 s47, s47, 10240000
    s_mul_i32 s14, s5, 9216
    s_add_u32 s44, s44, s14
sequential_preLN__ssm_conv_h3__dense_activation_relu__prompt_kernel_skip14:
    s_and_b32 s14, s2, 1
    s_lshl_b32 s24, s78, 16
    s_and_b32 s25, s78, 0xffff0000
    s_cmp_eq_u32 s14, 1
    s_cselect_b32 s24, s25, s24
    s_mov_b32 s25, s24
    s_lshl_b32 s26, s79, 16
    s_and_b32 s27, s79, 0xffff0000
    s_cmp_eq_u32 s14, 1
    s_cselect_b32 s26, s27, s26
    s_mov_b32 s27, s26
    s_lshl_b32 s28, s80, 16
    s_and_b32 s29, s80, 0xffff0000
    s_cmp_eq_u32 s14, 1
    s_cselect_b32 s28, s29, s28
    s_mov_b32 s29, s28
    s_mul_i32 s6, s2, 4096
    ds_read_b128 v[104:107], v9 offset:0
    ds_read_b128 v[108:111], v9 offset:256
    ds_read_b128 v[112:115], v9 offset:512
    ds_read_b128 v[116:119], v9 offset:768
    ds_read_b128 v[120:123], v9 offset:1024
    ds_read_b128 v[124:127], v9 offset:1280
    ds_read_b128 v[128:131], v9 offset:1536
    ds_read_b128 v[132:135], v9 offset:1792
    ds_read_b128 v[136:139], v9 offset:2048
    ds_read_b128 v[140:143], v9 offset:2304
    ds_read_b128 v[144:147], v9 offset:2560
    ds_read_b128 v[148:151], v9 offset:2816
    ds_read_b128 v[152:155], v9 offset:3072
    ds_read_b128 v[156:159], v9 offset:3328
    ds_read_b128 v[160:163], v9 offset:3584
    ds_read_b128 v[164:167], v9 offset:3840
    s_cmp_lg_u32 s5, 0
    s_cbranch_scc1 sequential_preLN__ssm_conv_h3__dense_activation_relu__prompt_kernel_skip17
    s_mov_b32 s7, 10289152
    s_mov_b32 s12, 400000
    buffer_load_dword v75, v73, s[64:67], s7 offen sc1
    s_waitcnt vmcnt(0)
sequential_preLN__ssm_conv_h3__dense_activation_relu__prompt_kernel_poll18:
    v_cmp_ne_u32 vcc, 64, v75
    s_nop 4
    s_cbranch_vccz sequential_preLN__ssm_conv_h3__dense_activation_relu__prompt_kernel_got19
    s_sub_u32 s12, s12, 1
    s_cmp_eq_u32 s12, 0
    s_cbranch_scc1 sequential_preLN__ssm_conv_h3__dense_activation_relu__prompt_kernel_got19
    s_sleep 2
    buffer_load_dword v75, v73, s[64:67], s7 offen sc1
    s_waitcnt vmcnt(0)
    s_branch sequential_preLN__ssm_conv_h3__dense_activation_relu__prompt_kernel_poll18
sequential_preLN__ssm_conv_h3__dense_activation_relu__prompt_kernel_got19:
sequential_preLN__ssm_conv_h3__dense_activation_relu__prompt_kernel_skip17:
    s_barrier
    s_cmp_ge_u32 s2, 64
    s_cselect_b32 s15, 0x7f000000, 0
    s_add_u32 s7, s6, 0
    s_add_u32 s7, s7, s8
    s_add_u32 m0, s8, 33280
    s_nop 0
    buffer_load_dwordx4 v4, s[64:67], s7 offen sc1 lds
    s_add_u32 s7, s6, 1048576
    s_add_u32 s7, s7, s8
    s_add_u32 m0, s8, 71168
    s_nop 0
    buffer_load_dwordx4 v4, s[64:67], s7 offen sc1 lds
    s_cmp_ge_u32 s2, 64
    s_cbranch_scc1 sequential_preLN__ssm_conv_h3__dense_activation_relu__prompt_kernel_skip20
    s_add_u32 s7, s6, 2097152
    s_add_u32 s7, s7, s8
    s_add_u32 m0, s8, 109056
    s_nop 0
    buffer_load_dwordx4 v4, s[64:67], s7 offen sc1 lds
sequential_preLN__ssm_conv_h3__dense_activation_relu__prompt_kernel_skip20:
    s_add_u32 s7, s6, 2621440
    s_add_u32 s7, s7, s8
    buffer_load_dwordx2 v[20:21], v7, s[64:67], s7 offen sc1
    buffer_load_dwordx2 v[22:23], v7, s[64:67], s7 offen offset:512 sc1
    s_add_u32 s7, s6, 3670016
    s_add_u32 s7, s7, s8
    buffer_load_dwordx2 v[24:25], v7, s[64:67], s7 offen sc1
    buffer_load_dwordx2 v[26:27], v7, s[64:67], s7 offen offset:512 sc1
    s_add_u32 s7, s6, 4718592
    s_add_u32 s7, s7, s8
    s_add_u32 s7, s7, s15
    buffer_load_dwordx2 v[28:29], v7, s[64:67], s7 offen sc1
    buffer_load_dwordx2 v[30:31], v7, s[64:67], s7 offen offset:512 sc1
    s_lshl_b32 s9, s5, 11
    s_add_u32 s9, s9, 10223616
    s_add_u32 s10, s9, 0x2000
    buffer_load_dwordx4 v[32:35], v8, s[64:67], s9 offen sc1
    buffer_load_dwordx4 v[36:39], v8, s[64:67], s9 offen offset:1024 sc1
    buffer_load_dwordx4 v[40:43], v8, s[64:67], s10 offen sc1
    buffer_load_dwordx4 v[44:47], v8, s[64:67], s10 offen offset:1024 sc1
    s_waitcnt vmcnt(0) lgkmcnt(0)
    s_barrier
    ds_read_b128 v[168:171], v10 offset:3840
    ds_read_b128 v[172:175], v10 offset:3584
    ds_read_b128 v[176:179], v10 offset:3328
    ds_read_b128 v[180:183], v10 offset:3072
    ds_read_b128 v[184:187], v10 offset:2816
    ds_read_b128 v[188:191], v10 offset:2560
    ds_read_b128 v[192:195], v10 offset:2304
    ds_read_b128 v[196:199], v10 offset:2048
    ds_read_b128 v[200:203], v10 offset:1792
    ds_read_b128 v[204:207], v10 offset:1536
    ds_read_b128 v[208:211], v10 offset:1280
    ds_read_b128 v[212:215], v10 offset:1024
    ds_read_b128 v[216:219], v10 offset:768
    ds_read_b128 v[220:223], v10 offset:512
    ds_read_b128 v[224:227], v10 offset:256
    ds_read_b128 v[228:231], v10 offset:0
    v_lshrrev_b32 v253, 3, v2
    v_and_b32 v254, 2, v253
    s_and_b32 s14, s5, 1
    s_lshl_b32 s14, s14, 2
    v_or_b32 v254, s14, v254
    v_and_b32 v255, 7, v2
    v_xor_b32 v254, v254, v255
    v_lshlrev_b32 v254, 4, v254
    v_mul_u32_u24 v255, 1152, v253
    v_add_u32 v255, v255, v254
    v_mul_u32_u24 v253, 9216, v253
    v_add_u32 v254, v253, v254
    s_mul_i32 s14, s5, 73728
    s_add_u32 s76, s76, s14
    s_waitcnt lgkmcnt(15)
    v_mfma_f32_16x16x32_bf16 a[0:3], v[108:111], v[168:171], 0
    s_cmp_ge_u32 s81, 144
    s_cbranch_scc1 sequential_preLN__ssm_conv_h3__dense_activation_relu__prompt_kernel_skip21
    s_add_u32 m0, s8, 113664
    s_nop 0
    buffer_load_dwordx4 v254, s[40:43], s76 offen lds
    s_add_u32 s76, s76, 294912
    s_add_u32 m0, s8, 117760
    s_nop 0
    buffer_load_dwordx4 v254, s[40:43], s76 offen lds
    s_add_u32 s76, s76, 294912
    s_add_u32 m0, s8, 121856
    s_nop 0
    buffer_load_dwordx4 v254, s[40:43], s76 offen lds
    s_add_u32 s76, s76, 294912
sequential_preLN__ssm_conv_h3__dense_activation_relu__prompt_kernel_skip21:
    ds_read_b128 a[96:99], v14 offset:0
    ds_read_b128 a[100:103], v14 offset:256
    v_mfma_f32_16x16x32_bf16 a[4:7], v[116:119], v[168:171], 0
    ds_read_b128 a[104:107], v14 offset:512
    ds_read_b128 a[108:111], v14 offset:768
    ds_read_b128 a[112:115], v14 offset:1024
    v_mfma_f32_16x16x32_bf16 a[8:11], v[124:127], v[168:171], 0
    ds_read_b128 a[116:119], v14 offset:1280
    ds_read_b128 a[120:123], v14 offset:1536
    ds_read_b128 a[124:127], v14 offset:1792
    v_mfma_f32_16x16x32_bf16 a[12:15], v[132:135], v[168:171], 0
    ds_read_b128 a[128:131], v14 offset:2048
    ds_read_b128 a[132:135], v14 offset:2304
    ds_read_b128 a[136:139], v14 offset:2560
    v_mfma_f32_16x16x32_bf16 a[16:19], v[140:143], v[168:171], 0
    ds_read_b128 a[140:143], v14 offset:2816
    ds_read_b128 a[144:147], v14 offset:3072
    ds_read_b128 a[148:151], v14 offset:3328
    v_mfma_f32_16x16x32_bf16 a[20:23], v[148:151], v[168:171], 0
    ds_read_b128 a[152:155], v14 offset:3584
    ds_read_b128 a[156:159], v14 offset:3840
    ds_read_b128 a[160:163], v15 offset:3840
    v_mfma_f32_16x16x32_bf16 a[24:27], v[156:159], v[168:171], 0
    ds_read_b128 a[164:167], v15 offset:3584
    ds_read_b128 a[168:171], v15 offset:3328
    ds_read_b128 a[172:175], v15 offset:3072
    v_mfma_f32_16x16x32_bf16 a[28:31], v[164:167], v[168:171], 0
    ds_read_b128 a[176:179], v15 offset:2816
    ds_read_b128 a[180:183], v15 offset:2560
    ds_read_b128 a[184:187], v15 offset:2304
    s_waitcnt lgkmcnt(15)
    v_mfma_f32_16x16x32_bf16 a[0:3], v[104:107], v[172:175], a[0:3]
    ds_read_b128 a[188:191], v15 offset:2048
    ds_read_b128 a[192:195], v15 offset:1792
    ds_read_b128 a[196:199], v15 offset:1536
    v_mfma_f32_16x16x32_bf16 a[4:7], v[112:115], v[172:175], a[4:7]
    ds_read_b128 a[200:203], v15 offset:1280
    ds_read_b128 a[204:207], v15 offset:1024
    ds_read_b128 a[208:211], v15 offset:768
    v_mfma_f32_16x16x32_bf16 a[8:11], v[120:123], v[172:175], a[8:11]
    ds_read_b128 a[212:215], v15 offset:512
    ds_read_b128 a[216:219], v15 offset:256
    s_cmp_ge_u32 s81, 144
    s_cbranch_scc1 sequential_preLN__ssm_conv_h3__dense_activation_relu__prompt_kernel_skip22
    s_add_u32 m0, s8, 125952
    s_nop 0
    buffer_load_dwordx4 v254, s[40:43], s76 offen lds
    s_add_u32 s76, s76, 294912
    s_add_u32 m0, s8, 130048
    s_nop 0
    buffer_load_dwordx4 v254, s[40:43], s76 offen lds
    s_add_u32 s76, s76, 294912
    s_add_u32 m0, s8, 134144
    s_nop 0
    buffer_load_dwordx4 v254, s[40:43], s76 offen lds
    s_add_u32 s76, s76, 294912
sequential_preLN__ssm_conv_h3__dense_activation_relu__prompt_kernel_skip22:
    v_mfma_f32_16x16x32_bf16 a[12:15], v[128:131], v[172:175], a[12:15]
    ds_read_b128 a[220:223], v15 offset:0
    ds_read_b64 v[240:241], v11 offset:512
    ds_read_b64 v[242:243], v11 offset:0
    v_mfma_f32_16x16x32_bf16 a[16:19], v[136:139], v[172:175], a[16:19]
    v_lshlrev_b32 v232, 16, v20
    v_and_b32 v233, 0xffff0000, v20
    v_sub_f32 v232, v232, v32
    v_mfma_f32_16x16x32_bf16 a[20:23], v[144:147], v[172:175], a[20:23]
    v_sub_f32 v233, v233, v33
    v_cvt_pk_bf16_f32 v238, v232, v233
    v_lshlrev_b32 v232, 16, v238
    v_mfma_f32_16x16x32_bf16 a[24:27], v[152:155], v[172:175], a[24:27]
    v_and_b32 v233, 0xffff0000, v238
    v_mul_f32 v232, v232, v40
    v_mul_f32 v233, v233, v41
    v_mfma_f32_16x16x32_bf16 a[28:31], v[160:163], v[172:175], a[28:31]
    v_cvt_pk_bf16_f32 v48, v232, v233
    v_lshlrev_b32 v232, 16, v21
    v_and_b32 v233, 0xffff0000, v21
    v_mfma_f32_16x16x32_bf16 a[4:7], v[108:111], v[176:179], a[4:7]
    v_sub_f32 v232, v232, v34
    v_sub_f32 v233, v233, v35
    v_cvt_pk_bf16_f32 v238, v232, v233
    v_mfma_f32_16x16x32_bf16 a[8:11], v[116:119], v[176:179], a[8:11]
    v_lshlrev_b32 v232, 16, v238
    v_and_b32 v233, 0xffff0000, v238
    v_mul_f32 v232, v232, v42
    v_mfma_f32_16x16x32_bf16 a[12:15], v[124:127], v[176:179], a[12:15]
    v_mul_f32 v233, v233, v43
    v_cvt_pk_bf16_f32 v49, v232, v233
    v_lshlrev_b32 v232, 16, v22
    v_mfma_f32_16x16x32_bf16 a[16:19], v[132:135], v[176:179], a[16:19]
    v_and_b32 v233, 0xffff0000, v22
    v_sub_f32 v232, v232, v36
    v_mfma_f32_16x16x32_bf16 a[20:23], v[140:143], v[176:179], a[20:23]
    v_sub_f32 v233, v233, v37
    v_cvt_pk_bf16_f32 v238, v232, v233
    v_mfma_f32_16x16x32_bf16 a[24:27], v[148:151], v[176:179], a[24:27]
    v_lshlrev_b32 v232, 16, v238
    v_and_b32 v233, 0xffff0000, v238
    v_mfma_f32_16x16x32_bf16 a[28:31], v[156:159], v[176:179], a[28:31]
    v_mul_f32 v232, v232, v44
    s_cmp_ge_u32 s81, 144
    s_cbranch_scc1 sequential_preLN__ssm_conv_h3__dense_activation_relu__prompt_kernel_skip23
    s_add_u32 m0, s8, 138240
    s_nop 0
    buffer_load_dwordx4 v254, s[40:43], s76 offen lds
    s_add_u32 s76, s76, 294912
    s_add_u32 m0, s8, 142336
    s_nop 0
    buffer_load_dwordx4 v254, s[40:43], s76 offen lds
    s_add_u32 s76, s76, 294912
    s_add_u32 m0, s8, 146432
    s_nop 0
    buffer_load_dwordx4 v254, s[40:43], s76 offen lds
    s_add_u32 s76, s76, 294912
sequential_preLN__ssm_conv_h3__dense_activation_relu__prompt_kernel_skip23:
    v_mfma_f32_16x16x32_bf16 a[4:7], v[104:107], v[180:183], a[4:7]
    v_mul_f32 v233, v233, v45
    v_cvt_pk_bf16_f32 v50, v232, v233
    v_mfma_f32_16x16x32_bf16 a[8:11], v[112:115], v[180:183], a[8:11]
    v_lshlrev_b32 v232, 16, v23
    v_and_b32 v233, 0xffff0000, v23
    v_mfma_f32_16x16x32_bf16 a[12:15], v[120:123], v[180:183], a[12:15]
    v_sub_f32 v232, v232, v38
    v_sub_f32 v233, v233, v39
    v_mfma_f32_16x16x32_bf16 a[16:19], v[128:131], v[180:183], a[16:19]
    v_cvt_pk_bf16_f32 v238, v232, v233
    v_lshlrev_b32 v232, 16, v238
    v_mfma_f32_16x16x32_bf16 a[20:23], v[136:139], v[180:183], a[20:23]
    v_and_b32 v233, 0xffff0000, v238
    v_mul_f32 v232, v232, v46
    v_mfma_f32_16x16x32_bf16 a[24:27], v[144:147], v[180:183], a[24:27]
    v_mul_f32 v233, v233, v47
    v_cvt_pk_bf16_f32 v51, v232, v233
    v_mfma_f32_16x16x32_bf16 a[28:31], v[152:155], v[180:183], a[28:31]
    s_waitcnt lgkmcnt(1)
    v_and_b32 v234, 0xffff0000, v241
    v_lshlrev_b32 v235, 16, v241
    v_mfma_f32_16x16x32_bf16 a[8:11], v[108:111], v[184:187], a[8:11]
    v_and_b32 v236, 0xffff0000, v240
    v_lshlrev_b32 v237, 16, v240
    v_mfma_f32_16x16x32_bf16 a[12:15], v[116:119], v[184:187], a[12:15]
    v_mul_f32 v234, s24, v234
    v_mul_f32 v235, s24, v235
    v_mfma_f32_16x16x32_bf16 a[16:19], v[124:127], v[184:187], a[16:19]
    v_cvt_pk_bf16_f32 v52, v234, v235
    v_mul_f32 v236, s24, v236
    v_mfma_f32_16x16x32_bf16 a[20:23], v[132:135], v[184:187], a[20:23]
    v_mul_f32 v237, s24, v237
    v_cvt_pk_bf16_f32 v53, v236, v237
    v_mfma_f32_16x16x32_bf16 a[24:27], v[140:143], v[184:187], a[24:27]
    s_waitcnt lgkmcnt(0)
    v_and_b32 v234, 0xffff0000, v243
    v_lshlrev_b32 v235, 16, v243
    v_mfma_f32_16x16x32_bf16 a[28:31], v[148:151], v[184:187], a[28:31]
    v_and_b32 v236, 0xffff0000, v242
    v_lshlrev_b32 v237, 16, v242
    v_mfma_f32_16x16x32_bf16 a[8:11], v[104:107], v[188:191], a[8:11]
    v_mul_f32 v234, s24, v234
    v_mul_f32 v235, s24, v235
    v_mfma_f32_16x16x32_bf16 a[12:15], v[112:115], v[188:191], a[12:15]
    v_cvt_pk_bf16_f32 v54, v234, v235
    v_mul_f32 v236, s24, v236
    v_mfma_f32_16x16x32_bf16 a[16:19], v[120:123], v[188:191], a[16:19]
    v_mul_f32 v237, s24, v237
    v_mfma_f32_16x16x32_bf16 a[20:23], v[128:131], v[188:191], a[20:23]
    v_cvt_pk_bf16_f32 v55, v236, v237
    ds_read_b64 v[240:241], v16 offset:512
    v_mfma_f32_16x16x32_bf16 a[24:27], v[136:139], v[188:191], a[24:27]
    ds_read_b64 v[242:243], v16 offset:0
    v_lshlrev_b32 v232, 16, v24
    v_mfma_f32_16x16x32_bf16 a[28:31], v[144:147], v[188:191], a[28:31]
    v_and_b32 v233, 0xffff0000, v24
    v_sub_f32 v232, v232, v32
    v_mfma_f32_16x16x32_bf16 a[12:15], v[108:111], v[192:195], a[12:15]
    v_sub_f32 v233, v233, v33
    v_cvt_pk_bf16_f32 v238, v232, v233
    v_mfma_f32_16x16x32_bf16 a[16:19], v[116:119], v[192:195], a[16:19]
    v_lshlrev_b32 v232, 16, v238
    v_and_b32 v233, 0xffff0000, v238
    v_mfma_f32_16x16x32_bf16 a[20:23], v[124:127], v[192:195], a[20:23]
    v_mul_f32 v232, v232, v40
    v_mul_f32 v233, v233, v41
    v_mfma_f32_16x16x32_bf16 a[24:27], v[132:135], v[192:195], a[24:27]
    v_cvt_pk_bf16_f32 v56, v232, v233
    v_lshlrev_b32 v232, 16, v25
    v_mfma_f32_16x16x32_bf16 a[28:31], v[140:143], v[192:195], a[28:31]
    v_and_b32 v233, 0xffff0000, v25
    v_sub_f32 v232, v232, v34
    v_mfma_f32_16x16x32_bf16 a[12:15], v[104:107], v[196:199], a[12:15]
    v_sub_f32 v233, v233, v35
    v_cvt_pk_bf16_f32 v238, v232, v233
    v_mfma_f32_16x16x32_bf16 a[16:19], v[112:115], v[196:199], a[16:19]
    v_lshlrev_b32 v232, 16, v238
    v_and_b32 v233, 0xffff0000, v238
    v_mfma_f32_16x16x32_bf16 a[20:23], v[120:123], v[196:199], a[20:23]
    v_mul_f32 v232, v232, v42
    v_mul_f32 v233, v233, v43
    v_mfma_f32_16x16x32_bf16 a[24:27], v[128:131], v[196:199], a[24:27]
    v_cvt_pk_bf16_f32 v57, v232, v233
    v_lshlrev_b32 v232, 16, v26
    v_mfma_f32_16x16x32_bf16 a[28:31], v[136:139], v[196:199], a[28:31]
    v_and_b32 v233, 0xffff0000, v26
    v_sub_f32 v232, v232, v36
    v_mfma_f32_16x16x32_bf16 a[16:19], v[108:111], v[200:203], a[16:19]
    v_sub_f32 v233, v233, v37
    v_cvt_pk_bf16_f32 v238, v232, v233
    v_mfma_f32_16x16x32_bf16 a[20:23], v[116:119], v[200:203], a[20:23]
    v_lshlrev_b32 v232, 16, v238
    v_and_b32 v233, 0xffff0000, v238
    v_mfma_f32_16x16x32_bf16 a[24:27], v[124:127], v[200:203], a[24:27]
    v_mul_f32 v232, v232, v44
    v_mfma_f32_16x16x32_bf16 a[28:31], v[132:135], v[200:203], a[28:31]
    v_mul_f32 v233, v233, v45
    v_cvt_pk_bf16_f32 v58, v232, v233
    v_mfma_f32_16x16x32_bf16 a[16:19], v[104:107], v[204:207], a[16:19]
    v_lshlrev_b32 v232, 16, v27
    v_and_b32 v233, 0xffff0000, v27
    v_mfma_f32_16x16x32_bf16 a[20:23], v[112:115], v[204:207], a[20:23]
    v_sub_f32 v232, v232, v38
    v_sub_f32 v233, v233, v39
    v_mfma_f32_16x16x32_bf16 a[24:27], v[120:123], v[204:207], a[24:27]
    v_cvt_pk_bf16_f32 v238, v232, v233
    v_lshlrev_b32 v232, 16, v238
    v_mfma_f32_16x16x32_bf16 a[28:31], v[128:131], v[204:207], a[28:31]
    v_and_b32 v233, 0xffff0000, v238
    v_mul_f32 v232, v232, v46
    v_mfma_f32_16x16x32_bf16 a[20:23], v[108:111], v[208:211], a[20:23]
    v_mul_f32 v233, v233, v47
    v_cvt_pk_bf16_f32 v59, v232, v233
    v_mfma_f32_16x16x32_bf16 a[24:27], v[116:119], v[208:211], a[24:27]
    s_waitcnt lgkmcnt(1)
    v_and_b32 v234, 0xffff0000, v241
    v_lshlrev_b32 v235, 16, v241
    v_mfma_f32_16x16x32_bf16 a[28:31], v[124:127], v[208:211], a[28:31]
    v_and_b32 v236, 0xffff0000, v240
    v_lshlrev_b32 v237, 16, v240
    v_mfma_f32_16x16x32_bf16 a[20:23], v[104:107], v[212:215], a[20:23]
    v_mul_f32 v234, s26, v234
    v_mul_f32 v235, s26, v235
    v_mfma_f32_16x16x32_bf16 a[24:27], v[112:115], v[212:215], a[24:27]
    v_cvt_pk_bf16_f32 v60, v234, v235
    v_mul_f32 v236, s26, v236
    v_mfma_f32_16x16x32_bf16 a[28:31], v[120:123], v[212:215], a[28:31]
    v_mul_f32 v237, s26, v237
    v_cvt_pk_bf16_f32 v61, v236, v237
    v_mfma_f32_16x16x32_bf16 a[24:27], v[108:111], v[216:219], a[24:27]
    s_waitcnt lgkmcnt(0)
    v_and_b32 v234, 0xffff0000, v243
    v_lshlrev_b32 v235, 16, v243
    v_mfma_f32_16x16x32_bf16 a[28:31], v[116:119], v[216:219], a[28:31]
    v_and_b32 v236, 0xffff0000, v242
    v_lshlrev_b32 v237, 16, v242
    v_mfma_f32_16x16x32_bf16 a[24:27], v[104:107], v[220:223], a[24:27]
    v_mul_f32 v234, s26, v234
    v_mul_f32 v235, s26, v235
    v_mfma_f32_16x16x32_bf16 a[28:31], v[112:115], v[220:223], a[28:31]
    v_cvt_pk_bf16_f32 v62, v234, v235
    v_mul_f32 v236, s26, v236
    v_mfma_f32_16x16x32_bf16 a[28:31], v[108:111], v[224:227], a[28:31]
    v_mul_f32 v237, s26, v237
    v_cvt_pk_bf16_f32 v63, v236, v237
    v_mfma_f32_16x16x32_bf16 a[28:31], v[104:107], v[228:231], a[28:31]
    v_mfma_f32_16x16x32_bf16 a[32:35], a[100:103], a[160:163], 0
    ds_write_b128 v13, a[0:3] offset:0
    ds_write_b128 v13, a[4:7] offset:4096
    ds_write_b128 v13, a[8:11] offset:8192
    v_mfma_f32_16x16x32_bf16 a[36:39], a[108:111], a[160:163], 0
    ds_write_b128 v13, a[12:15] offset:12288
    ds_write_b128 v13, a[16:19] offset:16384
    ds_write_b128 v13, a[20:23] offset:20480
    v_mfma_f32_16x16x32_bf16 a[40:43], a[116:119], a[160:163], 0
    ds_write_b128 v13, a[24:27] offset:24576
    ds_write_b128 v13, a[28:31] offset:28672
    ds_read_b128 v[104:107], v248 offset:0
    v_mfma_f32_16x16x32_bf16 a[44:47], a[124:127], a[160:163], 0
    ds_read_b128 v[108:111], v248 offset:256
    ds_read_b128 v[112:115], v248 offset:512
    ds_read_b128 v[116:119], v248 offset:768
    v_mfma_f32_16x16x32_bf16 a[48:51], a[132:135], a[160:163], 0
    ds_read_b128 v[120:123], v248 offset:1024
    ds_read_b128 v[124:127], v248 offset:1280
    ds_read_b128 v[128:131], v248 offset:1536
    v_mfma_f32_16x16x32_bf16 a[52:55], a[140:143], a[160:163], 0
    ds_read_b128 v[132:135], v248 offset:1792
    s_waitcnt lgkmcnt(0)
    s_barrier
    ds_read_b128 v[72:75], v12 offset:0
    v_mfma_f32_16x16x32_bf16 a[56:59], a[148:151], a[160:163], 0
    ds_read_b128 v[76:79], v12 offset:1024
    ds_read_b128 v[80:83], v12 offset:2048
    ds_read_b128 v[84:87], v12 offset:3072
    v_mfma_f32_16x16x32_bf16 a[60:63], a[156:159], a[160:163], 0
    ds_read_b128 v[88:91], v12 offset:4096
    ds_read_b128 v[92:95], v12 offset:5120
    ds_read_b128 v[96:99], v12 offset:6144
    v_mfma_f32_16x16x32_bf16 a[32:35], a[96:99], a[164:167], a[32:35]
    ds_read_b128 v[100:103], v12 offset:7168
    ds_read_b128 v[136:139], v248 offset:2048
    ds_read_b128 v[140:143], v248 offset:2304
    v_mfma_f32_16x16x32_bf16 a[36:39], a[104:107], a[164:167], a[36:39]
    ds_read_b128 v[144:147], v248 offset:2560
    ds_read_b128 v[148:151], v248 offset:2816
    ds_read_b128 v[152:155], v248 offset:3072
    v_mfma_f32_16x16x32_bf16 a[40:43], a[112:115], a[164:167], a[40:43]
    ds_read_b128 v[156:159], v248 offset:3328
    ds_read_b128 v[160:163], v248 offset:3584
    ds_read_b128 v[164:167], v248 offset:3840
    v_mfma_f32_16x16x32_bf16 a[44:47], a[120:123], a[164:167], a[44:47]
    ds_read_b128 v[168:171], v249 offset:3840
    ds_read_b128 v[172:175], v249 offset:3584
    ds_read_b128 v[176:179], v249 offset:3328
    v_mfma_f32_16x16x32_bf16 a[48:51], a[128:131], a[164:167], a[48:51]
    ds_read_b128 v[180:183], v249 offset:3072
    ds_read_b128 v[184:187], v249 offset:2816
    ds_read_b128 v[188:191], v249 offset:2560
    v_mfma_f32_16x16x32_bf16 a[52:55], a[136:139], a[164:167], a[52:55]
    ds_read_b128 v[192:195], v249 offset:2304
    ds_read_b128 v[196:199], v249 offset:2048
    ds_read_b128 v[200:203], v249 offset:1792
    v_mfma_f32_16x16x32_bf16 a[56:59], a[144:147], a[164:167], a[56:59]
    ds_read_b128 v[204:207], v249 offset:1536
    ds_read_b128 v[208:211], v249 offset:1280
    ds_read_b128 v[212:215], v249 offset:1024
    v_mfma_f32_16x16x32_bf16 a[60:63], a[152:155], a[164:167], a[60:63]
    ds_read_b128 v[216:219], v249 offset:768
    ds_read_b128 v[220:223], v249 offset:512
    ds_read_b128 v[224:227], v249 offset:256
    v_mfma_f32_16x16x32_bf16 a[36:39], a[100:103], a[168:171], a[36:39]
    ds_read_b128 v[228:231], v249 offset:0
    s_waitcnt lgkmcnt(15)
    v_add_f32 v72, v72, v76
    v_add_f32 v73, v73, v77
    v_mfma_f32_16x16x32_bf16 a[40:43], a[108:111], a[168:171], a[40:43]
    v_add_f32 v72, v72, v80
    v_add_f32 v73, v73, v81
    v_add_f32 v72, v72, v84
    v_mfma_f32_16x16x32_bf16 a[44:47], a[116:119], a[168:171], a[44:47]
    v_add_f32 v73, v73, v85
    v_cvt_pk_bf16_f32 v80, v72, v73
    v_lshlrev_b32 v72, 16, v80
    v_mfma_f32_16x16x32_bf16 a[48:51], a[124:127], a[168:171], a[48:51]
    v_and_b32 v73, 0xffff0000, v80
    v_lshlrev_b32 v76, 16, v52
    v_and_b32 v77, 0xffff0000, v52
    v_mfma_f32_16x16x32_bf16 a[52:55], a[132:135], a[168:171], a[52:55]
    v_add_f32 v72, v72, v76
    v_add_f32 v73, v73, v77
    v_cvt_pk_bf16_f32 v80, v72, v73
    v_mfma_f32_16x16x32_bf16 a[56:59], a[140:143], a[168:171], a[56:59]
    v_lshlrev_b32 v72, 16, v80
    v_and_b32 v73, 0xffff0000, v80
    v_lshlrev_b32 v76, 16, v48
    v_mfma_f32_16x16x32_bf16 a[60:63], a[148:151], a[168:171], a[60:63]
    v_and_b32 v77, 0xffff0000, v48
    v_mul_f32 v72, v72, v76
    v_mul_f32 v73, v73, v77
    v_mfma_f32_16x16x32_bf16 a[36:39], a[96:99], a[172:175], a[36:39]
    v_cvt_pk_bf16_f32 v80, v72, v73
    v_lshlrev_b32 v72, 16, v80
    v_and_b32 v73, 0xffff0000, v80
    v_mfma_f32_16x16x32_bf16 a[40:43], a[104:107], a[172:175], a[40:43]
    v_lshlrev_b32 v76, 16, v20
    v_and_b32 v77, 0xffff0000, v20
    v_mfma_f32_16x16x32_bf16 a[44:47], a[112:115], a[172:175], a[44:47]
    v_add_f32 v72, v72, v76
    v_add_f32 v73, v73, v77
    v_mfma_f32_16x16x32_bf16 a[48:51], a[120:123], a[172:175], a[48:51]
    v_cvt_pk_bf16_f32 v244, v72, v73
    v_add_f32 v74, v74, v78
    v_mfma_f32_16x16x32_bf16 a[52:55], a[128:131], a[172:175], a[52:55]
    v_add_f32 v75, v75, v79
    v_add_f32 v74, v74, v82
    v_mfma_f32_16x16x32_bf16 a[56:59], a[136:139], a[172:175], a[56:59]
    v_add_f32 v75, v75, v83
    v_add_f32 v74, v74, v86
    v_mfma_f32_16x16x32_bf16 a[60:63], a[144:147], a[172:175], a[60:63]
    v_add_f32 v75, v75, v87
    v_cvt_pk_bf16_f32 v82, v74, v75
    v_mfma_f32_16x16x32_bf16 a[40:43], a[100:103], a[176:179], a[40:43]
    v_lshlrev_b32 v74, 16, v82
    v_and_b32 v75, 0xffff0000, v82
    v_mfma_f32_16x16x32_bf16 a[44:47], a[108:111], a[176:179], a[44:47]
    v_lshlrev_b32 v78, 16, v53
    v_and_b32 v79, 0xffff0000, v53
    v_mfma_f32_16x16x32_bf16 a[48:51], a[116:119], a[176:179], a[48:51]
    v_add_f32 v74, v74, v78
    v_add_f32 v75, v75, v79
    v_mfma_f32_16x16x32_bf16 a[52:55], a[124:127], a[176:179], a[52:55]
    v_cvt_pk_bf16_f32 v82, v74, v75
    v_lshlrev_b32 v74, 16, v82
    v_mfma_f32_16x16x32_bf16 a[56:59], a[132:135], a[176:179], a[56:59]
    v_and_b32 v75, 0xffff0000, v82
    v_lshlrev_b32 v78, 16, v49
    v_mfma_f32_16x16x32_bf16 a[60:63], a[140:143], a[176:179], a[60:63]
    v_and_b32 v79, 0xffff0000, v49
    v_mul_f32 v74, v74, v78
    v_mfma_f32_16x16x32_bf16 a[40:43], a[96:99], a[180:183], a[40:43]
    v_mul_f32 v75, v75, v79
    v_cvt_pk_bf16_f32 v82, v74, v75
    v_mfma_f32_16x16x32_bf16 a[44:47], a[104:107], a[180:183], a[44:47]
    v_lshlrev_b32 v74, 16, v82
    v_and_b32 v75, 0xffff0000, v82
    v_mfma_f32_16x16x32_bf16 a[48:51], a[112:115], a[180:183], a[48:51]
    v_lshlrev_b32 v78, 16, v21
    v_and_b32 v79, 0xffff0000, v21
    v_mfma_f32_16x16x32_bf16 a[52:55], a[120:123], a[180:183], a[52:55]
    v_add_f32 v74, v74, v78
    v_add_f32 v75, v75, v79
    v_mfma_f32_16x16x32_bf16 a[56:59], a[128:131], a[180:183], a[56:59]
    v_cvt_pk_bf16_f32 v245, v74, v75
    v_add_f32 v88, v88, v92
    v_mfma_f32_16x16x32_bf16 a[60:63], a[136:139], a[180:183], a[60:63]
    v_add_f32 v89, v89, v93
    v_add_f32 v88, v88, v96
    v_mfma_f32_16x16x32_bf16 a[44:47], a[100:103], a[184:187], a[44:47]
    v_add_f32 v89, v89, v97
    v_add_f32 v88, v88, v100
    v_mfma_f32_16x16x32_bf16 a[48:51], a[108:111], a[184:187], a[48:51]
    v_add_f32 v89, v89, v101
    v_cvt_pk_bf16_f32 v96, v88, v89
    v_mfma_f32_16x16x32_bf16 a[52:55], a[116:119], a[184:187], a[52:55]
    v_lshlrev_b32 v88, 16, v96
    v_and_b32 v89, 0xffff0000, v96
    v_mfma_f32_16x16x32_bf16 a[56:59], a[124:127], a[184:187], a[56:59]
    v_lshlrev_b32 v92, 16, v54
    v_and_b32 v93, 0xffff0000, v54
    v_mfma_f32_16x16x32_bf16 a[60:63], a[132:135], a[184:187], a[60:63]
    v_add_f32 v88, v88, v92
    v_add_f32 v89, v89, v93
    v_mfma_f32_16x16x32_bf16 a[44:47], a[96:99], a[188:191], a[44:47]
    v_cvt_pk_bf16_f32 v96, v88, v89
    v_lshlrev_b32 v88, 16, v96
    v_mfma_f32_16x16x32_bf16 a[48:51], a[104:107], a[188:191], a[48:51]
    v_and_b32 v89, 0xffff0000, v96
    v_lshlrev_b32 v92, 16, v50
    v_mfma_f32_16x16x32_bf16 a[52:55], a[112:115], a[188:191], a[52:55]
    v_and_b32 v93, 0xffff0000, v50
    v_mul_f32 v88, v88, v92
    v_mfma_f32_16x16x32_bf16 a[56:59], a[120:123], a[188:191], a[56:59]
    v_mul_f32 v89, v89, v93
    v_cvt_pk_bf16_f32 v96, v88, v89
    v_mfma_f32_16x16x32_bf16 a[60:63], a[128:131], a[188:191], a[60:63]
    v_lshlrev_b32 v88, 16, v96
    v_and_b32 v89, 0xffff0000, v96
    v_mfma_f32_16x16x32_bf16 a[48:51], a[100:103], a[192:195], a[48:51]
    v_lshlrev_b32 v92, 16, v22
    v_and_b32 v93, 0xffff0000, v22
    v_mfma_f32_16x16x32_bf16 a[52:55], a[108:111], a[192:195], a[52:55]
    v_add_f32 v88, v88, v92
    v_add_f32 v89, v89, v93
    v_mfma_f32_16x16x32_bf16 a[56:59], a[116:119], a[192:195], a[56:59]
    v_cvt_pk_bf16_f32 v246, v88, v89
    v_add_f32 v90, v90, v94
    v_mfma_f32_16x16x32_bf16 a[60:63], a[124:127], a[192:195], a[60:63]
    v_add_f32 v91, v91, v95
    v_add_f32 v90, v90, v98
    v_mfma_f32_16x16x32_bf16 a[48:51], a[96:99], a[196:199], a[48:51]
    v_add_f32 v91, v91, v99
    v_add_f32 v90, v90, v102
    v_mfma_f32_16x16x32_bf16 a[52:55], a[104:107], a[196:199], a[52:55]
    v_add_f32 v91, v91, v103
    v_cvt_pk_bf16_f32 v98, v90, v91
    v_mfma_f32_16x16x32_bf16 a[56:59], a[112:115], a[196:199], a[56:59]
    v_lshlrev_b32 v90, 16, v98
    v_and_b32 v91, 0xffff0000, v98
    v_mfma_f32_16x16x32_bf16 a[60:63], a[120:123], a[196:199], a[60:63]
    v_lshlrev_b32 v94, 16, v55
    v_and_b32 v95, 0xffff0000, v55
    v_mfma_f32_16x16x32_bf16 a[52:55], a[100:103], a[200:203], a[52:55]
    v_add_f32 v90, v90, v94
    v_add_f32 v91, v91, v95
    v_mfma_f32_16x16x32_bf16 a[56:59], a[108:111], a[200:203], a[56:59]
    v_cvt_pk_bf16_f32 v98, v90, v91
    v_lshlrev_b32 v90, 16, v98
    v_mfma_f32_16x16x32_bf16 a[60:63], a[116:119], a[200:203], a[60:63]
    v_and_b32 v91, 0xffff0000, v98
    v_lshlrev_b32 v94, 16, v51
    v_mfma_f32_16x16x32_bf16 a[52:55], a[96:99], a[204:207], a[52:55]
    v_and_b32 v95, 0xffff0000, v51
    v_mul_f32 v90, v90, v94
    v_mfma_f32_16x16x32_bf16 a[56:59], a[104:107], a[204:207], a[56:59]
    v_mul_f32 v91, v91, v95
    v_cvt_pk_bf16_f32 v98, v90, v91
    v_mfma_f32_16x16x32_bf16 a[60:63], a[112:115], a[204:207], a[60:63]
    v_lshlrev_b32 v90, 16, v98
    v_and_b32 v91, 0xffff0000, v98
    v_mfma_f32_16x16x32_bf16 a[56:59], a[100:103], a[208:211], a[56:59]
    v_lshlrev_b32 v94, 16, v23
    v_and_b32 v95, 0xffff0000, v23
    v_mfma_f32_16x16x32_bf16 a[60:63], a[108:111], a[208:211], a[60:63]
    v_add_f32 v90, v90, v94
    v_add_f32 v91, v91, v95
    v_mfma_f32_16x16x32_bf16 a[56:59], a[96:99], a[212:215], a[56:59]
    v_cvt_pk_bf16_f32 v247, v90, v91
    s_add_u32 s7, s6, 5242880
    v_mfma_f32_16x16x32_bf16 a[60:63], a[104:107], a[212:215], a[60:63]
    s_add_u32 s7, s7, s8
    v_permlane16_swap_b32 v244, v246
    v_mfma_f32_16x16x32_bf16 a[60:63], a[100:103], a[216:219], a[60:63]
    v_permlane16_swap_b32 v245, v247
    buffer_store_dwordx4 v[244:247], v19, s[64:67], s7 offen sc1
    v_mfma_f32_16x16x32_bf16 a[60:63], a[96:99], a[220:223], a[60:63]
    s_cmp_ge_u32 s2, 64
    s_cbranch_scc1 sequential_preLN__ssm_conv_h3__dense_activation_relu__prompt_kernel_no324
    v_mfma_f32_16x16x32_bf16 a[64:67], v[108:111], v[168:171], 0
    ds_write_b128 v18, a[32:35] offset:0
    ds_write_b128 v18, a[36:39] offset:4096
    ds_write_b128 v18, a[40:43] offset:8192
    v_mfma_f32_16x16x32_bf16 a[68:71], v[116:119], v[168:171], 0
    ds_write_b128 v18, a[44:47] offset:12288
    ds_write_b128 v18, a[48:51] offset:16384
    ds_write_b128 v18, a[52:55] offset:20480
    v_mfma_f32_16x16x32_bf16 a[72:75], v[124:127], v[168:171], 0
    ds_write_b128 v18, a[56:59] offset:24576
    ds_write_b128 v18, a[60:63] offset:28672
    ds_read_b64 v[240:241], v250 offset:512
    v_mfma_f32_16x16x32_bf16 a[76:79], v[132:135], v[168:171], 0
    ds_read_b64 v[242:243], v250 offset:0
    v_lshlrev_b32 v232, 16, v28
    v_and_b32 v233, 0xffff0000, v28
    v_mfma_f32_16x16x32_bf16 a[80:83], v[140:143], v[168:171], 0
    v_sub_f32 v232, v232, v32
    v_sub_f32 v233, v233, v33
    v_cvt_pk_bf16_f32 v238, v232, v233
    v_mfma_f32_16x16x32_bf16 a[84:87], v[148:151], v[168:171], 0
    v_lshlrev_b32 v232, 16, v238
    v_and_b32 v233, 0xffff0000, v238
    v_mul_f32 v232, v232, v40
    v_mfma_f32_16x16x32_bf16 a[88:91], v[156:159], v[168:171], 0
    s_waitcnt lgkmcnt(0)
    s_barrier
    ds_read_b128 v[72:75], v17 offset:0
    ds_read_b128 v[76:79], v17 offset:1024
    v_mfma_f32_16x16x32_bf16 a[92:95], v[164:167], v[168:171], 0
    ds_read_b128 v[80:83], v17 offset:2048
    ds_read_b128 v[84:87], v17 offset:3072
    ds_read_b128 v[88:91], v17 offset:4096
    v_mfma_f32_16x16x32_bf16 a[64:67], v[104:107], v[172:175], a[64:67]
    ds_read_b128 v[92:95], v17 offset:5120
    ds_read_b128 v[96:99], v17 offset:6144
    ds_read_b128 v[100:103], v17 offset:7168
    v_mfma_f32_16x16x32_bf16 a[68:71], v[112:115], v[172:175], a[68:71]
    v_mul_f32 v233, v233, v41
    v_cvt_pk_bf16_f32 v64, v232, v233
    v_lshlrev_b32 v232, 16, v29
    v_mfma_f32_16x16x32_bf16 a[72:75], v[120:123], v[172:175], a[72:75]
    v_and_b32 v233, 0xffff0000, v29
    v_sub_f32 v232, v232, v34
    v_sub_f32 v233, v233, v35
    v_mfma_f32_16x16x32_bf16 a[76:79], v[128:131], v[172:175], a[76:79]
    v_cvt_pk_bf16_f32 v238, v232, v233
    v_lshlrev_b32 v232, 16, v238
    v_and_b32 v233, 0xffff0000, v238
    v_mfma_f32_16x16x32_bf16 a[80:83], v[136:139], v[172:175], a[80:83]
    v_mul_f32 v232, v232, v42
    v_mul_f32 v233, v233, v43
    v_cvt_pk_bf16_f32 v65, v232, v233
    v_mfma_f32_16x16x32_bf16 a[84:87], v[144:147], v[172:175], a[84:87]
    v_lshlrev_b32 v232, 16, v30
    v_and_b32 v233, 0xffff0000, v30
    v_sub_f32 v232, v232, v36
    v_mfma_f32_16x16x32_bf16 a[88:91], v[152:155], v[172:175], a[88:91]
    v_sub_f32 v233, v233, v37
    v_cvt_pk_bf16_f32 v238, v232, v233
    v_lshlrev_b32 v232, 16, v238
    v_mfma_f32_16x16x32_bf16 a[92:95], v[160:163], v[172:175], a[92:95]
    v_and_b32 v233, 0xffff0000, v238
    v_mul_f32 v232, v232, v44
    v_mul_f32 v233, v233, v45
    v_mfma_f32_16x16x32_bf16 a[68:71], v[108:111], v[176:179], a[68:71]
    v_cvt_pk_bf16_f32 v66, v232, v233
    v_lshlrev_b32 v232, 16, v31
    v_and_b32 v233, 0xffff0000, v31
    v_mfma_f32_16x16x32_bf16 a[72:75], v[116:119], v[176:179], a[72:75]
    v_sub_f32 v232, v232, v38
    v_sub_f32 v233, v233, v39
    v_cvt_pk_bf16_f32 v238, v232, v233
    v_mfma_f32_16x16x32_bf16 a[76:79], v[124:127], v[176:179], a[76:79]
    v_lshlrev_b32 v232, 16, v238
    v_and_b32 v233, 0xffff0000, v238
    v_mul_f32 v232, v232, v46
    v_mfma_f32_16x16x32_bf16 a[80:83], v[132:135], v[176:179], a[80:83]
    v_mul_f32 v233, v233, v47
    v_cvt_pk_bf16_f32 v67, v232, v233
    v_and_b32 v234, 0xffff0000, v241
    v_mfma_f32_16x16x32_bf16 a[84:87], v[140:143], v[176:179], a[84:87]
    v_lshlrev_b32 v235, 16, v241
    v_and_b32 v236, 0xffff0000, v240
    v_lshlrev_b32 v237, 16, v240
    v_mfma_f32_16x16x32_bf16 a[88:91], v[148:151], v[176:179], a[88:91]
    v_mul_f32 v234, s28, v234
    v_mul_f32 v235, s28, v235
    v_cvt_pk_bf16_f32 v68, v234, v235
    v_mfma_f32_16x16x32_bf16 a[92:95], v[156:159], v[176:179], a[92:95]
    v_mul_f32 v236, s28, v236
    v_mul_f32 v237, s28, v237
    v_cvt_pk_bf16_f32 v69, v236, v237
    v_mfma_f32_16x16x32_bf16 a[68:71], v[104:107], v[180:183], a[68:71]
    v_and_b32 v234, 0xffff0000, v243
    v_lshlrev_b32 v235, 16, v243
    v_and_b32 v236, 0xffff0000, v242
    v_mfma_f32_16x16x32_bf16 a[72:75], v[112:115], v[180:183], a[72:75]
    v_lshlrev_b32 v237, 16, v242
    v_mul_f32 v234, s28, v234
    v_mul_f32 v235, s28, v235
    v_mfma_f32_16x16x32_bf16 a[76:79], v[120:123], v[180:183], a[76:79]
    v_cvt_pk_bf16_f32 v70, v234, v235
    v_mul_f32 v236, s28, v236
    v_mul_f32 v237, s28, v237
    v_mfma_f32_16x16x32_bf16 a[80:83], v[128:131], v[180:183], a[80:83]
    v_cvt_pk_bf16_f32 v71, v236, v237
    s_waitcnt lgkmcnt(4)
    v_add_f32 v72, v72, v76
    v_add_f32 v73, v73, v77
    v_mfma_f32_16x16x32_bf16 a[84:87], v[136:139], v[180:183], a[84:87]
    v_add_f32 v72, v72, v80
    v_add_f32 v73, v73, v81
    v_add_f32 v72, v72, v84
    v_mfma_f32_16x16x32_bf16 a[88:91], v[144:147], v[180:183], a[88:91]
    v_add_f32 v73, v73, v85
    v_cvt_pk_bf16_f32 v80, v72, v73
    v_lshlrev_b32 v72, 16, v80
    v_mfma_f32_16x16x32_bf16 a[92:95], v[152:155], v[180:183], a[92:95]
    v_and_b32 v73, 0xffff0000, v80
    v_lshlrev_b32 v76, 16, v60
    v_and_b32 v77, 0xffff0000, v60
    v_mfma_f32_16x16x32_bf16 a[72:75], v[108:111], v[184:187], a[72:75]
    v_add_f32 v72, v72, v76
    v_add_f32 v73, v73, v77
    v_cvt_pk_bf16_f32 v80, v72, v73
    v_mfma_f32_16x16x32_bf16 a[76:79], v[116:119], v[184:187], a[76:79]
    v_lshlrev_b32 v72, 16, v80
    v_and_b32 v73, 0xffff0000, v80
    v_lshlrev_b32 v76, 16, v56
    v_mfma_f32_16x16x32_bf16 a[80:83], v[124:127], v[184:187], a[80:83]
    v_and_b32 v77, 0xffff0000, v56
    v_mul_f32 v72, v72, v76
    v_mul_f32 v73, v73, v77
    v_mfma_f32_16x16x32_bf16 a[84:87], v[132:135], v[184:187], a[84:87]
    v_cvt_pk_bf16_f32 v80, v72, v73
    v_lshlrev_b32 v72, 16, v80
    v_and_b32 v73, 0xffff0000, v80
    v_mfma_f32_16x16x32_bf16 a[88:91], v[140:143], v[184:187], a[88:91]
    v_lshlrev_b32 v76, 16, v24
    v_and_b32 v77, 0xffff0000, v24
    v_add_f32 v72, v72, v76
    v_mfma_f32_16x16x32_bf16 a[92:95], v[148:151], v[184:187], a[92:95]
    v_add_f32 v73, v73, v77
    v_cvt_pk_bf16_f32 v244, v72, v73
    v_add_f32 v74, v74, v78
    v_mfma_f32_16x16x32_bf16 a[72:75], v[104:107], v[188:191], a[72:75]
    v_add_f32 v75, v75, v79
    v_add_f32 v74, v74, v82
    v_add_f32 v75, v75, v83
    v_mfma_f32_16x16x32_bf16 a[76:79], v[112:115], v[188:191], a[76:79]
    v_add_f32 v74, v74, v86
    v_add_f32 v75, v75, v87
    v_cvt_pk_bf16_f32 v82, v74, v75
    v_mfma_f32_16x16x32_bf16 a[80:83], v[120:123], v[188:191], a[80:83]
    v_lshlrev_b32 v74, 16, v82
    v_and_b32 v75, 0xffff0000, v82
    v_lshlrev_b32 v78, 16, v61
    v_mfma_f32_16x16x32_bf16 a[84:87], v[128:131], v[188:191], a[84:87]
    v_and_b32 v79, 0xffff0000, v61
    v_add_f32 v74, v74, v78
    v_add_f32 v75, v75, v79
    v_mfma_f32_16x16x32_bf16 a[88:91], v[136:139], v[188:191], a[88:91]
    v_cvt_pk_bf16_f32 v82, v74, v75
    v_lshlrev_b32 v74, 16, v82
    v_and_b32 v75, 0xffff0000, v82
    v_mfma_f32_16x16x32_bf16 a[92:95], v[144:147], v[188:191], a[92:95]
    v_lshlrev_b32 v78, 16, v57
    v_and_b32 v79, 0xffff0000, v57
    v_mul_f32 v74, v74, v78
    v_mfma_f32_16x16x32_bf16 a[76:79], v[108:111], v[192:195], a[76:79]
    v_mul_f32 v75, v75, v79
    v_cvt_pk_bf16_f32 v82, v74, v75
    v_lshlrev_b32 v74, 16, v82
    v_mfma_f32_16x16x32_bf16 a[80:83], v[116:119], v[192:195], a[80:83]
    v_and_b32 v75, 0xffff0000, v82
    v_lshlrev_b32 v78, 16, v25
    v_and_b32 v79, 0xffff0000, v25
    v_mfma_f32_16x16x32_bf16 a[84:87], v[124:127], v[192:195], a[84:87]
    v_add_f32 v74, v74, v78
    v_add_f32 v75, v75, v79
    v_cvt_pk_bf16_f32 v245, v74, v75
    v_mfma_f32_16x16x32_bf16 a[88:91], v[132:135], v[192:195], a[88:91]
    s_waitcnt lgkmcnt(0)
    v_add_f32 v88, v88, v92
    v_add_f32 v89, v89, v93
    v_add_f32 v88, v88, v96
    v_mfma_f32_16x16x32_bf16 a[92:95], v[140:143], v[192:195], a[92:95]
    v_add_f32 v89, v89, v97
    v_add_f32 v88, v88, v100
    v_add_f32 v89, v89, v101
    v_mfma_f32_16x16x32_bf16 a[76:79], v[104:107], v[196:199], a[76:79]
    v_cvt_pk_bf16_f32 v96, v88, v89
    v_lshlrev_b32 v88, 16, v96
    v_and_b32 v89, 0xffff0000, v96
    v_mfma_f32_16x16x32_bf16 a[80:83], v[112:115], v[196:199], a[80:83]
    v_lshlrev_b32 v92, 16, v62
    v_and_b32 v93, 0xffff0000, v62
    v_add_f32 v88, v88, v92
    v_mfma_f32_16x16x32_bf16 a[84:87], v[120:123], v[196:199], a[84:87]
    v_add_f32 v89, v89, v93
    v_cvt_pk_bf16_f32 v96, v88, v89
    v_lshlrev_b32 v88, 16, v96
    v_mfma_f32_16x16x32_bf16 a[88:91], v[128:131], v[196:199], a[88:91]
    v_and_b32 v89, 0xffff0000, v96
    v_lshlrev_b32 v92, 16, v58
    v_and_b32 v93, 0xffff0000, v58
    v_mfma_f32_16x16x32_bf16 a[92:95], v[136:139], v[196:199], a[92:95]
    v_mul_f32 v88, v88, v92
    v_mul_f32 v89, v89, v93
    v_cvt_pk_bf16_f32 v96, v88, v89
    v_mfma_f32_16x16x32_bf16 a[80:83], v[108:111], v[200:203], a[80:83]
    v_lshlrev_b32 v88, 16, v96
    v_and_b32 v89, 0xffff0000, v96
    v_lshlrev_b32 v92, 16, v26
    v_mfma_f32_16x16x32_bf16 a[84:87], v[116:119], v[200:203], a[84:87]
    v_and_b32 v93, 0xffff0000, v26
    v_add_f32 v88, v88, v92
    v_add_f32 v89, v89, v93
    v_mfma_f32_16x16x32_bf16 a[88:91], v[124:127], v[200:203], a[88:91]
    v_cvt_pk_bf16_f32 v246, v88, v89
    v_add_f32 v90, v90, v94
    v_mfma_f32_16x16x32_bf16 a[92:95], v[132:135], v[200:203], a[92:95]
    v_add_f32 v91, v91, v95
    v_add_f32 v90, v90, v98
    v_mfma_f32_16x16x32_bf16 a[80:83], v[104:107], v[204:207], a[80:83]
    v_add_f32 v91, v91, v99
    v_add_f32 v90, v90, v102
    v_mfma_f32_16x16x32_bf16 a[84:87], v[112:115], v[204:207], a[84:87]
    v_add_f32 v91, v91, v103
    v_cvt_pk_bf16_f32 v98, v90, v91
    v_mfma_f32_16x16x32_bf16 a[88:91], v[120:123], v[204:207], a[88:91]
    v_lshlrev_b32 v90, 16, v98
    v_and_b32 v91, 0xffff0000, v98
    v_mfma_f32_16x16x32_bf16 a[92:95], v[128:131], v[204:207], a[92:95]
    v_lshlrev_b32 v94, 16, v63
    v_and_b32 v95, 0xffff0000, v63
    v_mfma_f32_16x16x32_bf16 a[84:87], v[108:111], v[208:211], a[84:87]
    v_add_f32 v90, v90, v94
    v_add_f32 v91, v91, v95
    v_mfma_f32_16x16x32_bf16 a[88:91], v[116:119], v[208:211], a[88:91]
    v_cvt_pk_bf16_f32 v98, v90, v91
    v_lshlrev_b32 v90, 16, v98
    v_mfma_f32_16x16x32_bf16 a[92:95], v[124:127], v[208:211], a[92:95]
    v_and_b32 v91, 0xffff0000, v98
    v_lshlrev_b32 v94, 16, v59
    v_mfma_f32_16x16x32_bf16 a[84:87], v[104:107], v[212:215], a[84:87]
    v_and_b32 v95, 0xffff0000, v59
    v_mul_f32 v90, v90, v94
    v_mfma_f32_16x16x32_bf16 a[88:91], v[112:115], v[212:215], a[88:91]
    v_mul_f32 v91, v91, v95
    v_cvt_pk_bf16_f32 v98, v90, v91
    v_mfma_f32_16x16x32_bf16 a[92:95], v[120:123], v[212:215], a[92:95]
    v_lshlrev_b32 v90, 16, v98
    v_and_b32 v91, 0xffff0000, v98
    v_mfma_f32_16x16x32_bf16 a[88:91], v[108:111], v[216:219], a[88:91]
    v_lshlrev_b32 v94, 16, v27
    v_and_b32 v95, 0xffff0000, v27
    v_mfma_f32_16x16x32_bf16 a[92:95], v[116:119], v[216:219], a[92:95]
    v_add_f32 v90, v90, v94
    v_add_f32 v91, v91, v95
    v_mfma_f32_16x16x32_bf16 a[88:91], v[104:107], v[220:223], a[88:91]
    v_cvt_pk_bf16_f32 v247, v90, v91
    s_add_u32 s7, s6, 6291456
    v_mfma_f32_16x16x32_bf16 a[92:95], v[112:115], v[220:223], a[92:95]
    s_add_u32 s7, s7, s8
    v_permlane16_swap_b32 v244, v246
    v_mfma_f32_16x16x32_bf16 a[92:95], v[108:111], v[224:227], a[92:95]
    v_permlane16_swap_b32 v245, v247
    buffer_store_dwordx4 v[244:247], v19, s[64:67], s7 offen sc1
    v_mfma_f32_16x16x32_bf16 a[92:95], v[104:107], v[228:231], a[92:95]
    ds_write_b128 v252, a[64:67] offset:0
    ds_write_b128 v252, a[68:71] offset:4096
    ds_write_b128 v252, a[72:75] offset:8192
    ds_write_b128 v252, a[76:79] offset:12288
    ds_write_b128 v252, a[80:83] offset:16384
    ds_write_b128 v252, a[84:87] offset:20480
    ds_write_b128 v252, a[88:91] offset:24576
    s_nop 0
    ds_write_b128 v252, a[92:95] offset:28672
    s_waitcnt lgkmcnt(0)
    s_barrier
    ds_read_b128 v[72:75], v251 offset:0
    ds_read_b128 v[76:79], v251 offset:1024
    ds_read_b128 v[80:83], v251 offset:2048
    ds_read_b128 v[84:87], v251 offset:3072
    ds_read_b128 v[88:91], v251 offset:4096
    ds_read_b128 v[92:95], v251 offset:5120
    ds_read_b128 v[96:99], v251 offset:6144
    ds_read_b128 v[100:103], v251 offset:7168
    s_waitcnt lgkmcnt(4)
    v_pk_add_f32 v[72:73], v[72:73], v[76:77]
    v_pk_add_f32 v[72:73], v[72:73], v[80:81]
    v_pk_add_f32 v[72:73], v[72:73], v[84:85]
    v_cvt_pk_bf16_f32 v80, v72, v73
    v_lshlrev_b32 v72, 16, v80
    v_and_b32 v73, 0xffff0000, v80
    v_lshlrev_b32 v76, 16, v68
    v_and_b32 v77, 0xffff0000, v68
    v_pk_add_f32 v[72:73], v[72:73], v[76:77]
    v_cvt_pk_bf16_f32 v80, v72, v73
    v_lshlrev_b32 v72, 16, v80
    v_and_b32 v73, 0xffff0000, v80
    v_lshlrev_b32 v76, 16, v64
    v_and_b32 v77, 0xffff0000, v64
    v_pk_mul_f32 v[72:73], v[72:73], v[76:77]
    v_cvt_pk_bf16_f32 v80, v72, v73
    v_lshlrev_b32 v72, 16, v80
    v_and_b32 v73, 0xffff0000, v80
    v_lshlrev_b32 v76, 16, v28
    v_and_b32 v77, 0xffff0000, v28
    v_pk_add_f32 v[72:73], v[72:73], v[76:77]
    v_cvt_pk_bf16_f32 v244, v72, v73
    v_pk_add_f32 v[74:75], v[74:75], v[78:79]
    v_pk_add_f32 v[74:75], v[74:75], v[82:83]
    v_pk_add_f32 v[74:75], v[74:75], v[86:87]
    v_cvt_pk_bf16_f32 v82, v74, v75
    v_lshlrev_b32 v74, 16, v82
    v_and_b32 v75, 0xffff0000, v82
    v_lshlrev_b32 v78, 16, v69
    v_and_b32 v79, 0xffff0000, v69
    v_pk_add_f32 v[74:75], v[74:75], v[78:79]
    v_cvt_pk_bf16_f32 v82, v74, v75
    v_lshlrev_b32 v74, 16, v82
    v_and_b32 v75, 0xffff0000, v82
    v_lshlrev_b32 v78, 16, v65
    v_and_b32 v79, 0xffff0000, v65
    v_pk_mul_f32 v[74:75], v[74:75], v[78:79]
    v_cvt_pk_bf16_f32 v82, v74, v75
    v_lshlrev_b32 v74, 16, v82
    v_and_b32 v75, 0xffff0000, v82
    v_lshlrev_b32 v78, 16, v29
    v_and_b32 v79, 0xffff0000, v29
    v_pk_add_f32 v[74:75], v[74:75], v[78:79]
    v_cvt_pk_bf16_f32 v245, v74, v75
    s_waitcnt lgkmcnt(0)
    v_pk_add_f32 v[88:89], v[88:89], v[92:93]
    v_pk_add_f32 v[88:89], v[88:89], v[96:97]
    v_pk_add_f32 v[88:89], v[88:89], v[100:101]
    v_cvt_pk_bf16_f32 v96, v88, v89
    v_lshlrev_b32 v88, 16, v96
    v_and_b32 v89, 0xffff0000, v96
    v_lshlrev_b32 v92, 16, v70
    v_and_b32 v93, 0xffff0000, v70
    v_pk_add_f32 v[88:89], v[88:89], v[92:93]
    v_cvt_pk_bf16_f32 v96, v88, v89
    v_lshlrev_b32 v88, 16, v96
    v_and_b32 v89, 0xffff0000, v96
    v_lshlrev_b32 v92, 16, v66
    v_and_b32 v93, 0xffff0000, v66
    v_pk_mul_f32 v[88:89], v[88:89], v[92:93]
    v_cvt_pk_bf16_f32 v96, v88, v89
    v_lshlrev_b32 v88, 16, v96
    v_and_b32 v89, 0xffff0000, v96
    v_lshlrev_b32 v92, 16, v30
    v_and_b32 v93, 0xffff0000, v30
    v_pk_add_f32 v[88:89], v[88:89], v[92:93]
    v_cvt_pk_bf16_f32 v246, v88, v89
    v_pk_add_f32 v[90:91], v[90:91], v[94:95]
    v_pk_add_f32 v[90:91], v[90:91], v[98:99]
    v_pk_add_f32 v[90:91], v[90:91], v[102:103]
    v_cvt_pk_bf16_f32 v98, v90, v91
    v_lshlrev_b32 v90, 16, v98
    v_and_b32 v91, 0xffff0000, v98
    v_lshlrev_b32 v94, 16, v71
    v_and_b32 v95, 0xffff0000, v71
    v_pk_add_f32 v[90:91], v[90:91], v[94:95]
    v_cvt_pk_bf16_f32 v98, v90, v91
    v_lshlrev_b32 v90, 16, v98
    v_and_b32 v91, 0xffff0000, v98
    v_lshlrev_b32 v94, 16, v67
    v_and_b32 v95, 0xffff0000, v67
    v_pk_mul_f32 v[90:91], v[90:91], v[94:95]
    v_cvt_pk_bf16_f32 v98, v90, v91
    v_lshlrev_b32 v90, 16, v98
    v_and_b32 v91, 0xffff0000, v98
    v_lshlrev_b32 v94, 16, v31
    v_and_b32 v95, 0xffff0000, v31
    v_pk_add_f32 v[90:91], v[90:91], v[94:95]
    v_cvt_pk_bf16_f32 v247, v90, v91
    s_add_u32 s7, s6, 7340032
    s_add_u32 s7, s7, s8
    v_permlane16_swap_b32 v244, v246
    v_permlane16_swap_b32 v245, v247
    buffer_store_dwordx4 v[244:247], v19, s[64:67], s7 offen sc1
    s_branch sequential_preLN__ssm_conv_h3__dense_activation_relu__prompt_kernel_j325
sequential_preLN__ssm_conv_h3__dense_activation_relu__prompt_kernel_no324:
    ds_write_b128 v18, a[32:35] offset:0
    ds_write_b128 v18, a[36:39] offset:4096
    ds_write_b128 v18, a[40:43] offset:8192
    ds_write_b128 v18, a[44:47] offset:12288
    ds_write_b128 v18, a[48:51] offset:16384
    ds_write_b128 v18, a[52:55] offset:20480
    ds_write_b128 v18, a[56:59] offset:24576
    ds_write_b128 v18, a[60:63] offset:28672
    s_waitcnt lgkmcnt(0)
    s_barrier
    ds_read_b128 v[72:75], v17 offset:0
    ds_read_b128 v[76:79], v17 offset:1024
    ds_read_b128 v[80:83], v17 offset:2048
    ds_read_b128 v[84:87], v17 offset:3072
    ds_read_b128 v[88:91], v17 offset:4096
    ds_read_b128 v[92:95], v17 offset:5120
    ds_read_b128 v[96:99], v17 offset:6144
    ds_read_b128 v[100:103], v17 offset:7168
    s_waitcnt lgkmcnt(4)
    v_pk_add_f32 v[72:73], v[72:73], v[76:77]
    v_pk_add_f32 v[72:73], v[72:73], v[80:81]
    v_pk_add_f32 v[72:73], v[72:73], v[84:85]
    v_cvt_pk_bf16_f32 v80, v72, v73
    v_lshlrev_b32 v72, 16, v80
    v_and_b32 v73, 0xffff0000, v80
    v_lshlrev_b32 v76, 16, v60
    v_and_b32 v77, 0xffff0000, v60
    v_pk_add_f32 v[72:73], v[72:73], v[76:77]
    v_cvt_pk_bf16_f32 v80, v72, v73
    v_lshlrev_b32 v72, 16, v80
    v_and_b32 v73, 0xffff0000, v80
    v_lshlrev_b32 v76, 16, v56
    v_and_b32 v77, 0xffff0000, v56
    v_pk_mul_f32 v[72:73], v[72:73], v[76:77]
    v_cvt_pk_bf16_f32 v80, v72, v73
    v_lshlrev_b32 v72, 16, v80
    v_and_b32 v73, 0xffff0000, v80
    v_lshlrev_b32 v76, 16, v24
    v_and_b32 v77, 0xffff0000, v24
    v_pk_add_f32 v[72:73], v[72:73], v[76:77]
    v_cvt_pk_bf16_f32 v244, v72, v73
    v_pk_add_f32 v[74:75], v[74:75], v[78:79]
    v_pk_add_f32 v[74:75], v[74:75], v[82:83]
    v_pk_add_f32 v[74:75], v[74:75], v[86:87]
    v_cvt_pk_bf16_f32 v82, v74, v75
    v_lshlrev_b32 v74, 16, v82
    v_and_b32 v75, 0xffff0000, v82
    v_lshlrev_b32 v78, 16, v61
    v_and_b32 v79, 0xffff0000, v61
    v_pk_add_f32 v[74:75], v[74:75], v[78:79]
    v_cvt_pk_bf16_f32 v82, v74, v75
    v_lshlrev_b32 v74, 16, v82
    v_and_b32 v75, 0xffff0000, v82
    v_lshlrev_b32 v78, 16, v57
    v_and_b32 v79, 0xffff0000, v57
    v_pk_mul_f32 v[74:75], v[74:75], v[78:79]
    v_cvt_pk_bf16_f32 v82, v74, v75
    v_lshlrev_b32 v74, 16, v82
    v_and_b32 v75, 0xffff0000, v82
    v_lshlrev_b32 v78, 16, v25
    v_and_b32 v79, 0xffff0000, v25
    v_pk_add_f32 v[74:75], v[74:75], v[78:79]
    v_cvt_pk_bf16_f32 v245, v74, v75
    s_waitcnt lgkmcnt(0)
    v_pk_add_f32 v[88:89], v[88:89], v[92:93]
    v_pk_add_f32 v[88:89], v[88:89], v[96:97]
    v_pk_add_f32 v[88:89], v[88:89], v[100:101]
    v_cvt_pk_bf16_f32 v96, v88, v89
    v_lshlrev_b32 v88, 16, v96
    v_and_b32 v89, 0xffff0000, v96
    v_lshlrev_b32 v92, 16, v62
    v_and_b32 v93, 0xffff0000, v62
    v_pk_add_f32 v[88:89], v[88:89], v[92:93]
    v_cvt_pk_bf16_f32 v96, v88, v89
    v_lshlrev_b32 v88, 16, v96
    v_and_b32 v89, 0xffff0000, v96
    v_lshlrev_b32 v92, 16, v58
    v_and_b32 v93, 0xffff0000, v58
    v_pk_mul_f32 v[88:89], v[88:89], v[92:93]
    v_cvt_pk_bf16_f32 v96, v88, v89
    v_lshlrev_b32 v88, 16, v96
    v_and_b32 v89, 0xffff0000, v96
    v_lshlrev_b32 v92, 16, v26
    v_and_b32 v93, 0xffff0000, v26
    v_pk_add_f32 v[88:89], v[88:89], v[92:93]
    v_cvt_pk_bf16_f32 v246, v88, v89
    v_pk_add_f32 v[90:91], v[90:91], v[94:95]
    v_pk_add_f32 v[90:91], v[90:91], v[98:99]
    v_pk_add_f32 v[90:91], v[90:91], v[102:103]
    v_cvt_pk_bf16_f32 v98, v90, v91
    v_lshlrev_b32 v90, 16, v98
    v_and_b32 v91, 0xffff0000, v98
    v_lshlrev_b32 v94, 16, v63
    v_and_b32 v95, 0xffff0000, v63
    v_pk_add_f32 v[90:91], v[90:91], v[94:95]
    v_cvt_pk_bf16_f32 v98, v90, v91
    v_lshlrev_b32 v90, 16, v98
    v_and_b32 v91, 0xffff0000, v98
    v_lshlrev_b32 v94, 16, v59
    v_and_b32 v95, 0xffff0000, v59
    v_pk_mul_f32 v[90:91], v[90:91], v[94:95]
    v_cvt_pk_bf16_f32 v98, v90, v91
    v_lshlrev_b32 v90, 16, v98
    v_and_b32 v91, 0xffff0000, v98
    v_lshlrev_b32 v94, 16, v27
    v_and_b32 v95, 0xffff0000, v27
    v_pk_add_f32 v[90:91], v[90:91], v[94:95]
    v_cvt_pk_bf16_f32 v247, v90, v91
    s_add_u32 s7, s6, 6291456
    s_add_u32 s7, s7, s8
    v_permlane16_swap_b32 v244, v246
    v_permlane16_swap_b32 v245, v247
    buffer_store_dwordx4 v[244:247], v19, s[64:67], s7 offen sc1
    s_cmp_ge_u32 s81, 144
    s_cbranch_scc1 sequential_preLN__ssm_conv_h3__dense_activation_relu__prompt_kernel_skip26
    s_mov_b32 s52, s47
    s_mov_b32 s53, s48
    s_mov_b32 s54, s49
    s_mov_b32 s47, s82
    s_mov_b32 s48, 1
    s_mov_b32 s49, s83
    s_mov_b32 s100, 113664
    s_waitcnt vmcnt(2)
    s_barrier
    v_bfe_u32 v150, v2, 2, 2
    v_and_b32 v151, 3, v2
    v_lshl_add_u32 v152, v6, 3, v150
    v_lshlrev_b32 v152, 7, v152
    v_lshrrev_b32 v150, 1, v150
    v_and_b32 v153, 1, v6
    v_lshl_or_b32 v150, v153, 1, v150
    v_lshlrev_b32 v150, 1, v150
    v_lshrrev_b32 v153, 1, v151
    s_lshl_b32 s45, s5, 1
    v_add_u32 v153, s45, v153
    v_xor_b32 v153, v153, v150
    v_lshlrev_b32 v153, 4, v153
    v_and_b32 v154, 1, v151
    v_lshl_add_u32 v153, v154, 3, v153
    s_lshr_b32 s45, s5, 1
    s_lshl_b32 s45, s45, 2
    v_or_b32 v151, s45, v151
    v_xor_b32 v151, v151, v150
    v_lshlrev_b32 v151, 4, v151
    s_and_b32 s45, s5, 1
    s_lshl_b32 s45, s45, 3
    v_add_u32 v151, s45, v151
    s_cmp_eq_u32 s48, 1
    s_cselect_b64 vcc, -1, 0
    v_cndmask_b32 v151, v151, v153, vcc
    v_add3_u32 v152, v152, v151, s100
    v_mov_b32 v154, 0x3f803f80
    v_mov_b32 v155, 0x3f803f80
    v_mov_b32 v156, 0x3f803f80
    v_mov_b32 v157, 0x3f803f80
    ds_read_b64_tr_b16 v[104:105], v152 offset:0
    ds_read_b64_tr_b16 v[106:107], v152 offset:512
    ds_read_b64_tr_b16 v[108:109], v152 offset:4096
    ds_read_b64_tr_b16 v[110:111], v152 offset:4608
    ds_read_b64_tr_b16 v[112:113], v152 offset:8192
    ds_read_b64_tr_b16 v[114:115], v152 offset:8704
    ds_read_b64_tr_b16 v[116:117], v152 offset:12288
    ds_read_b64_tr_b16 v[118:119], v152 offset:12800
    ds_read_b64_tr_b16 v[120:121], v152 offset:16384
    ds_read_b64_tr_b16 v[122:123], v152 offset:16896
    ds_read_b64_tr_b16 v[124:125], v152 offset:20480
    ds_read_b64_tr_b16 v[126:127], v152 offset:20992
    ds_read_b64_tr_b16 v[128:129], v152 offset:24576
    ds_read_b64_tr_b16 v[130:131], v152 offset:25088
    ds_read_b64_tr_b16 v[132:133], v152 offset:28672
    ds_read_b64_tr_b16 v[134:135], v152 offset:29184
    ds_read_b64_tr_b16 v[136:137], v152 offset:32768
    ds_read_b64_tr_b16 v[138:139], v152 offset:33280
    s_waitcnt lgkmcnt(15)
    buffer_store_dwordx4 v[104:107], v4, s[64:67], s49 offen offset:0 sc1
    v_mfma_f32_16x16x32_bf16 v[158:161], v[104:107], v[154:157], 0
    s_waitcnt lgkmcnt(14)
    buffer_store_dwordx4 v[108:111], v4, s[64:67], s49 offen offset:1024 sc1
    v_mfma_f32_16x16x32_bf16 v[158:161], v[108:111], v[154:157], v[158:161]
    s_waitcnt lgkmcnt(12)
    buffer_store_dwordx4 v[112:115], v4, s[64:67], s49 offen offset:2048 sc1
    v_mfma_f32_16x16x32_bf16 v[158:161], v[112:115], v[154:157], v[158:161]
    s_waitcnt lgkmcnt(10)
    buffer_store_dwordx4 v[116:119], v4, s[64:67], s49 offen offset:3072 sc1
    s_add_u32 s49, s49, 4096
    v_mfma_f32_16x16x32_bf16 v[158:161], v[116:119], v[154:157], v[158:161]
    s_waitcnt lgkmcnt(8)
    buffer_store_dwordx4 v[120:123], v4, s[64:67], s49 offen offset:0 sc1
    v_mfma_f32_16x16x32_bf16 v[158:161], v[120:123], v[154:157], v[158:161]
    s_waitcnt lgkmcnt(6)
    buffer_store_dwordx4 v[124:127], v4, s[64:67], s49 offen offset:1024 sc1
    v_mfma_f32_16x16x32_bf16 v[158:161], v[124:127], v[154:157], v[158:161]
    s_waitcnt lgkmcnt(4)
    buffer_store_dwordx4 v[128:131], v4, s[64:67], s49 offen offset:2048 sc1
    v_mfma_f32_16x16x32_bf16 v[158:161], v[128:131], v[154:157], v[158:161]
    s_waitcnt lgkmcnt(2)
    buffer_store_dwordx4 v[132:135], v4, s[64:67], s49 offen offset:3072 sc1
    s_add_u32 s49, s49, 4096
    v_mfma_f32_16x16x32_bf16 v[158:161], v[132:135], v[154:157], v[158:161]
    s_waitcnt lgkmcnt(0)
    buffer_store_dwordx4 v[136:139], v4, s[64:67], s49 offen offset:0 sc1
    v_mfma_f32_16x16x32_bf16 v[158:161], v[136:139], v[154:157], v[158:161]
    s_cmp_lg_u32 s48, 1
    s_cbranch_scc1 sequential_preLN__ssm_conv_h3__dense_activation_relu__prompt_kernel_skip27
    v_cmp_eq_u32 vcc, 0, v5
    v_lshlrev_b32 v150, 4, v6
    s_and_saveexec_b64 s[50:51], vcc
    s_nop 2
    buffer_store_dwordx4 v[158:161], v150, s[64:67], s47 offen sc1
    s_mov_b64 exec, s[50:51]
sequential_preLN__ssm_conv_h3__dense_activation_relu__prompt_kernel_skip27:
    s_mov_b32 s47, s52
    s_mov_b32 s48, s53
    s_mov_b32 s49, s54
sequential_preLN__ssm_conv_h3__dense_activation_relu__prompt_kernel_skip26:
sequential_preLN__ssm_conv_h3__dense_activation_relu__prompt_kernel_j325:
    s_and_b32 s3, s2, 1
    s_lshl_b32 s3, s3, 2
    s_bfe_u32 s4, s2, 0x20003
    s_add_u32 s3, s3, s4
    s_bfe_u32 s4, s2, 0x20001
    s_lshl_b32 s4, s4, 3
    s_lshr_b32 s6, s2, 5
    s_add_u32 s4, s4, s6
    v_lshrrev_b32 v3, 3, v2
    v_mul_u32_u24 v7, 4096, v3
    v_and_b32 v3, 2, v3
    s_and_b32 s6, s5, 1
    s_lshl_b32 s6, s6, 2
    v_or_b32 v3, s6, v3
    v_and_b32 v8, 7, v2
    v_xor_b32 v3, v3, v8
    v_lshl_add_u32 v3, v3, 4, v7
    s_mul_i32 s6, s5, 32768
    s_lshl_b32 s7, s4, 7
    s_add_u32 s6, s6, s7
    s_add_u32 s6, s6, 5242880
    s_mov_b32 s7, s8
    s_mul_i32 s8, s4, 13108
    s_lshr_b32 s8, s8, 16
    s_mul_i32 s8, s8, 5
    s_sub_u32 s8, s4, s8
    s_lshl_b32 s8, s8, 1
    s_mul_i32 s9, s3, 36
    s_mul_i32 s10, s5, 9
    s_add_u32 s9, s9, s10
    s_lshl_b32 s11, s9, 6
    s_add_u32 s11, s11, 10240000
    s_mul_i32 s9, s9, 18432
    s_add_u32 s9, s9, 10485760
    s_and_b32 s13, s2, 3
    s_lshl_b32 s13, s13, 7
    v_lshlrev_b32 v60, 9, v2
    v_add_u32 v60, s13, v60
    s_bfe_u32 s13, s2, 0x40002
    s_lshl_b32 s13, s13, 9
    v_and_b32 v61, 3, v2
    v_lshlrev_b32 v61, 7, v61
    v_add_u32 v61, s13, v61
    v_mov_b32 v19, 1
    s_mov_b32 s22, 10297344
    s_mov_b32 s23, 10305536
    s_waitcnt vmcnt(0)
    s_barrier
    s_cmp_lg_u32 s5, 0
    s_cbranch_scc1 sequential_preLN__ssm_conv_h3__dense_activation_relu__prompt_kernel_skip28
    s_mov_b64 exec, 0xffff
    buffer_atomic_add v19, v60, s[64:67], s23 offen
    s_mov_b64 exec, -1
    buffer_load_dword v62, v61, s[64:67], s23 offen sc1
sequential_preLN__ssm_conv_h3__dense_activation_relu__prompt_kernel_skip28:
    s_cmp_lt_u32 s2, 112
    s_cbranch_scc1 sequential_preLN__ssm_conv_h3__dense_activation_relu__prompt_kernel_skip29
    s_add_u32 m0, s7, 75776
    s_nop 0
    buffer_load_dwordx4 v255, s[60:63], s44 offen lds
    s_add_u32 s44, s44, 36864
    s_add_u32 m0, s7, 79872
    s_nop 0
    buffer_load_dwordx4 v255, s[60:63], s44 offen lds
    s_add_u32 s44, s44, 36864
    s_add_u32 m0, s7, 83968
    s_nop 0
    buffer_load_dwordx4 v255, s[60:63], s44 offen lds
    s_add_u32 s44, s44, 36864
    s_add_u32 m0, s7, 88064
    s_nop 0
    buffer_load_dwordx4 v255, s[60:63], s44 offen lds
    s_add_u32 s44, s44, 36864
    s_add_u32 m0, s7, 92160
    s_nop 0
    buffer_load_dwordx4 v255, s[60:63], s44 offen lds
    s_add_u32 s44, s44, 36864
    s_add_u32 m0, s7, 96256
    s_nop 0
    buffer_load_dwordx4 v255, s[60:63], s44 offen lds
    s_add_u32 s44, s44, 36864
    s_add_u32 m0, s7, 100352
    s_nop 0
    buffer_load_dwordx4 v255, s[60:63], s44 offen lds
    s_add_u32 s44, s44, 36864
    s_add_u32 m0, s7, 104448
    s_nop 0
    buffer_load_dwordx4 v255, s[60:63], s44 offen lds
    s_add_u32 s44, s44, 36864
    s_add_u32 m0, s7, 108544
    s_nop 0
    buffer_load_dwordx4 v255, s[60:63], s44 offen lds
    s_add_u32 s44, s44, 36864
sequential_preLN__ssm_conv_h3__dense_activation_relu__prompt_kernel_skip29:
    s_mov_b32 s101, s11
    v_bfe_u32 v7, v2, 2, 2
    v_and_b32 v8, 3, v2
    v_lshl_add_u32 v9, v6, 3, v7
    v_lshlrev_b32 v9, 7, v9
    v_lshl_add_u32 v9, v8, 3, v9
    v_lshrrev_b32 v7, 1, v7
    v_and_b32 v8, 1, v6
    v_lshl_or_b32 v7, v8, 1, v7
    v_mul_u32_u24 v10, 1184, v5
    v_lshl_add_u32 v10, v6, 3, v10
    s_mul_i32 s11, s5, 288
    s_add_u32 s11, s11, 73728
    v_lshlrev_b32 v11, 3, v5
    s_add_u32 s12, s5, 0
    s_and_b32 s12, s12, 3
    v_xor_b32 v8, s12, v7
    v_lshl_add_u32 v20, v8, 5, v9
    s_mul_i32 s13, s12, 18944
    s_add_u32 s13, s13, s11
    v_add_u32 v24, s13, v10
    s_lshl_b32 s13, s12, 10
    v_add_u32 v32, s13, v4
    s_lshl_b32 s13, s12, 7
    s_add_u32 s13, s13, 149504
    v_add_u32 v12, s13, v11
    s_add_u32 s12, s5, 1
    s_and_b32 s12, s12, 3
    v_xor_b32 v8, s12, v7
    v_lshl_add_u32 v21, v8, 5, v9
    s_mul_i32 s13, s12, 18944
    s_add_u32 s13, s13, s11
    v_add_u32 v25, s13, v10
    s_lshl_b32 s13, s12, 10
    v_add_u32 v33, s13, v4
    s_lshl_b32 s13, s12, 7
    s_add_u32 s13, s13, 149504
    v_add_u32 v13, s13, v11
    s_add_u32 s12, s5, 2
    s_and_b32 s12, s12, 3
    v_xor_b32 v8, s12, v7
    v_lshl_add_u32 v22, v8, 5, v9
    s_mul_i32 s13, s12, 18944
    s_add_u32 s13, s13, s11
    v_add_u32 v26, s13, v10
    s_lshl_b32 s13, s12, 10
    v_add_u32 v34, s13, v4
    s_lshl_b32 s13, s12, 7
    s_add_u32 s13, s13, 149504
    v_add_u32 v14, s13, v11
    s_add_u32 s12, s5, 3
    s_and_b32 s12, s12, 3
    v_xor_b32 v8, s12, v7
    v_lshl_add_u32 v23, v8, 5, v9
    s_mul_i32 s13, s12, 18944
    s_add_u32 s13, s13, s11
    v_add_u32 v27, s13, v10
    s_lshl_b32 s13, s12, 10
    v_add_u32 v35, s13, v4
    s_lshl_b32 s13, s12, 7
    s_add_u32 s13, s13, 149504
    v_add_u32 v15, s13, v11
    v_lshlrev_b32 v16, 4, v6
    s_add_u32 s13, s7, 155648
    v_add_u32 v16, s13, v16
    v_mov_b32 v68, 0x3f803f80
    v_mov_b32 v69, 0x3f803f80
    v_mov_b32 v70, 0x3f803f80
    v_mov_b32 v71, 0x3f803f80
    s_mul_i32 s16, s3, 2621440
    s_mul_i32 s19, s4, 81920
    s_add_u32 s19, s19, 22020096
    s_add_u32 s16, s16, s19
    s_add_u32 s17, s5, 16
    s_lshl_b32 s17, s17, 12
    s_lshl_b32 s18, s5, 14
    s_mov_b32 s14, 0
    v_mov_b32 v11, v61
    v_mov_b32 v10, v60
    s_mov_b32 s100, 75776
    s_mov_b32 s48, 0
    v_bfe_u32 v36, v2, 2, 2
    v_and_b32 v37, 3, v2
    v_lshl_add_u32 v38, v6, 3, v36
    v_lshlrev_b32 v38, 7, v38
    v_lshrrev_b32 v36, 1, v36
    v_and_b32 v39, 1, v6
    v_lshl_or_b32 v36, v39, 1, v36
    v_lshlrev_b32 v36, 1, v36
    v_lshrrev_b32 v39, 1, v37
    s_lshl_b32 s45, s5, 1
    v_add_u32 v39, s45, v39
    v_xor_b32 v39, v39, v36
    v_lshlrev_b32 v39, 4, v39
    v_and_b32 v40, 1, v37
    v_lshl_add_u32 v39, v40, 3, v39
    s_lshr_b32 s45, s5, 1
    s_lshl_b32 s45, s45, 2
    v_or_b32 v37, s45, v37
    v_xor_b32 v37, v37, v36
    v_lshlrev_b32 v37, 4, v37
    s_and_b32 s45, s5, 1
    s_lshl_b32 s45, s45, 3
    v_add_u32 v37, s45, v37
    s_cmp_eq_u32 s48, 1
    s_cselect_b64 vcc, -1, 0
    v_cndmask_b32 v37, v37, v39, vcc
    v_add3_u32 v38, v38, v37, s100
    s_cmp_lt_u32 s2, 112
    s_cselect_b32 s49, 0x7f000000, s49
    s_cmp_lg_u32 s5, 0
    s_cbranch_scc1 sequential_preLN__ssm_conv_h3__dense_activation_relu__prompt_kernel_skip30
    s_mov_b32 s12, 400000
    s_waitcnt vmcnt(0)
sequential_preLN__ssm_conv_h3__dense_activation_relu__prompt_kernel_poll31:
    v_cmp_ne_u32 vcc, 64, v62
    s_nop 4
    s_cbranch_vccz sequential_preLN__ssm_conv_h3__dense_activation_relu__prompt_kernel_got32
    s_sub_u32 s12, s12, 1
    s_cmp_eq_u32 s12, 0
    s_cbranch_scc1 sequential_preLN__ssm_conv_h3__dense_activation_relu__prompt_kernel_got32
    s_sleep 2
    buffer_load_dword v62, v61, s[64:67], s23 offen sc1
    s_waitcnt vmcnt(0)
    s_branch sequential_preLN__ssm_conv_h3__dense_activation_relu__prompt_kernel_poll31
sequential_preLN__ssm_conv_h3__dense_activation_relu__prompt_kernel_got32:
sequential_preLN__ssm_conv_h3__dense_activation_relu__prompt_kernel_skip30:
    s_barrier
    s_mul_i32 s10, s8, 18432
    s_add_u32 s10, s10, s9
    s_add_u32 m0, s7, 0
    s_nop 0
    buffer_load_dwordx4 v3, s[64:67], s6 offen sc1 lds
    s_add_u32 s6, s6, 131072
    s_add_u32 m0, s7, 4096
    s_nop 0
    buffer_load_dwordx4 v3, s[64:67], s6 offen sc1 lds
    s_add_u32 s6, s6, 131072
    s_add_u32 m0, s7, 8192
    s_nop 0
    buffer_load_dwordx4 v3, s[64:67], s6 offen sc1 lds
    s_add_u32 s6, s6, 131072
    s_add_u32 m0, s7, 12288
    s_nop 0
    buffer_load_dwordx4 v3, s[64:67], s6 offen sc1 lds
    s_add_u32 s6, s6, 131072
    s_add_u32 m0, s7, 16384
    s_nop 0
    buffer_load_dwordx4 v3, s[64:67], s6 offen sc1 lds
    s_add_u32 s6, s6, 131072
    s_add_u32 m0, s7, 20480
    s_nop 0
    buffer_load_dwordx4 v3, s[64:67], s6 offen sc1 lds
    s_add_u32 s6, s6, 131072
    buffer_load_dwordx4 v[112:115], v4, s[64:67], s10 offen offset:0 sc1
    buffer_load_dwordx4 v[116:119], v4, s[64:67], s10 offen offset:1024 sc1
    buffer_load_dwordx4 v[120:123], v4, s[64:67], s10 offen offset:2048 sc1
    buffer_load_dwordx4 v[124:127], v4, s[64:67], s10 offen offset:3072 sc1
    s_add_u32 s10, s10, 4096
    buffer_load_dwordx4 v[128:131], v4, s[64:67], s10 offen offset:0 sc1
    buffer_load_dwordx4 v[132:135], v4, s[64:67], s10 offen offset:1024 sc1
    s_add_u32 m0, s7, 24576
    s_nop 0
    buffer_load_dwordx4 v3, s[64:67], s6 offen sc1 lds
    s_add_u32 s6, s6, 131072
    s_add_u32 m0, s7, 28672
    s_nop 0
    buffer_load_dwordx4 v3, s[64:67], s6 offen sc1 lds
    s_add_u32 s6, s6, 131072
    s_add_u32 m0, s7, 32768
    s_nop 0
    buffer_load_dwordx4 v3, s[64:67], s6 offen sc1 lds
    s_add_u32 s6, s6, 131072
    s_add_u32 m0, s7, 36864
    s_nop 0
    buffer_load_dwordx4 v3, s[64:67], s6 offen sc1 lds
    s_add_u32 s6, s6, 131072
    s_add_u32 m0, s7, 40960
    s_nop 0
    buffer_load_dwordx4 v3, s[64:67], s6 offen sc1 lds
    s_add_u32 s6, s6, 131072
    s_add_u32 m0, s7, 45056
    s_nop 0
    buffer_load_dwordx4 v3, s[64:67], s6 offen sc1 lds
    s_add_u32 s6, s6, 131072
    buffer_load_dwordx4 v[136:139], v4, s[64:67], s10 offen offset:2048 sc1
    buffer_load_dwordx4 v[140:143], v4, s[64:67], s10 offen offset:3072 sc1
    s_add_u32 s10, s10, 4096
    buffer_load_dwordx4 v[144:147], v4, s[64:67], s10 offen offset:0 sc1
    buffer_load_dwordx4 v[148:151], v4, s[64:67], s10 offen offset:1024 sc1
    buffer_load_dwordx4 v[152:155], v4, s[64:67], s10 offen offset:2048 sc1
    buffer_load_dwordx4 v[156:159], v4, s[64:67], s10 offen offset:3072 sc1
    s_add_u32 s10, s10, 4096
    s_add_u32 m0, s7, 49152
    s_nop 0
    buffer_load_dwordx4 v3, s[64:67], s6 offen sc1 lds
    s_add_u32 s6, s6, 131072
    s_add_u32 m0, s7, 53248
    s_nop 0
    buffer_load_dwordx4 v3, s[64:67], s6 offen sc1 lds
    s_add_u32 s6, s6, 131072
    s_add_u32 m0, s7, 57344
    s_nop 0
    buffer_load_dwordx4 v3, s[64:67], s6 offen sc1 lds
    s_add_u32 s6, s6, 131072
    s_add_u32 m0, s7, 61440
    s_nop 0
    buffer_load_dwordx4 v3, s[64:67], s6 offen sc1 lds
    s_add_u32 s6, s6, 131072
    s_add_u32 m0, s7, 65536
    s_nop 0
    buffer_load_dwordx4 v3, s[64:67], s6 offen sc1 lds
    s_add_u32 s6, s6, 131072
    s_add_u32 m0, s7, 69632
    s_nop 0
    buffer_load_dwordx4 v3, s[64:67], s6 offen sc1 lds
    buffer_load_dwordx4 v[160:163], v4, s[64:67], s10 offen offset:0 sc1
    buffer_load_dwordx4 v[164:167], v4, s[64:67], s10 offen offset:1024 sc1
    buffer_load_dwordx4 v[168:171], v4, s[64:67], s10 offen offset:2048 sc1
    buffer_load_dwordx4 v[172:175], v4, s[64:67], s10 offen offset:3072 sc1
    s_add_u32 s10, s10, 4096
    buffer_load_dwordx4 v[176:179], v4, s[64:67], s10 offen offset:0 sc1
    s_add_u32 m0, s7, 155648
    s_nop 0
    buffer_load_dwordx4 v4, s[64:67], s101 offen sc1 lds
    s_add_u32 s101, s101, 18432
    s_add_u32 m0, s7, 159744
    s_nop 0
    buffer_load_dwordx4 v4, s[64:67], s101 offen sc1 lds
    s_waitcnt vmcnt(31)
    s_barrier
    s_mov_b32 s22, 10313728
    ds_read_b64_tr_b16 v[184:185], v20 offset:0
    ds_read_b64_tr_b16 v[186:187], v20 offset:512
    ds_read_b64_tr_b16 a[0:1], v21 offset:0
    ds_read_b64_tr_b16 a[2:3], v21 offset:512
    ds_read_b64_tr_b16 a[72:73], v22 offset:0
    ds_read_b64_tr_b16 a[74:75], v22 offset:512
    ds_read_b64_tr_b16 a[144:145], v23 offset:0
    ds_read_b64_tr_b16 a[146:147], v23 offset:512
    ds_read_b64_tr_b16 v[188:189], v20 offset:4096
    ds_read_b64_tr_b16 v[190:191], v20 offset:4608
    ds_read_b64_tr_b16 a[4:5], v21 offset:4096
    ds_read_b64_tr_b16 a[6:7], v21 offset:4608
    ds_read_b64_tr_b16 a[76:77], v22 offset:4096
    ds_read_b64_tr_b16 a[78:79], v22 offset:4608
    ds_read_b64_tr_b16 a[148:149], v23 offset:4096
    ds_read_b64_tr_b16 a[150:151], v23 offset:4608
    s_waitcnt vmcnt(30)
    s_waitcnt lgkmcnt(8)
    ds_read_b64_tr_b16 a[216:217], v38 offset:0
    v_mfma_f32_16x16x32_bf16 v[96:99], v[112:115], v[184:187], 0
    buffer_load_dwordx4 v[180:183], v4, s[64:67], s10 offen offset:1024 sc1
    ds_read_b64_tr_b16 a[218:219], v38 offset:512
    ds_read_b64_tr_b16 v[192:193], v20 offset:8192
    v_mfma_f32_16x16x32_bf16 v[100:103], v[112:115], a[0:3], 0
    s_add_u32 s15, s8, 1
    s_cmp_eq_u32 s15, 9
    s_cselect_b32 s15, 0, s15
    v_mfma_f32_16x16x32_bf16 v[104:107], v[112:115], a[72:75], 0
    s_mul_i32 s10, s15, 18432
    s_add_u32 s10, s10, s9
    ds_read_b64_tr_b16 v[194:195], v20 offset:8704
    v_mfma_f32_16x16x32_bf16 v[108:111], v[112:115], a[144:147], 0
    ds_read_b64_tr_b16 a[8:9], v21 offset:8192
    ds_read_b64_tr_b16 a[10:11], v21 offset:8704
    ds_read_b64_tr_b16 a[80:81], v22 offset:8192
    v_mfma_f32_16x16x32_bf16 v[72:75], v[68:71], v[184:187], 0
    ds_read_b64_tr_b16 a[82:83], v22 offset:8704
    ds_read_b64_tr_b16 a[152:153], v23 offset:8192
    ds_read_b64_tr_b16 a[154:155], v23 offset:8704
    v_mfma_f32_16x16x32_bf16 v[76:79], v[184:187], v[184:187], 0
    s_waitcnt vmcnt(30)
    s_waitcnt lgkmcnt(8)
    ds_read_b64_tr_b16 a[220:221], v38 offset:4096
    v_mfma_f32_16x16x32_bf16 v[96:99], v[116:119], v[188:191], v[96:99]
    buffer_load_dwordx4 v[112:115], v4, s[64:67], s10 offen offset:0 sc1
    ds_read_b64_tr_b16 a[222:223], v38 offset:4608
    ds_read_b64_tr_b16 v[196:197], v20 offset:12288
    v_mfma_f32_16x16x32_bf16 v[100:103], v[116:119], a[4:7], v[100:103]
    ds_read_b64_tr_b16 v[198:199], v20 offset:12800
    ds_read_b64_tr_b16 a[12:13], v21 offset:12288
    ds_read_b64_tr_b16 a[14:15], v21 offset:12800
    v_mfma_f32_16x16x32_bf16 v[104:107], v[116:119], a[76:79], v[104:107]
    ds_read_b64_tr_b16 a[84:85], v22 offset:12288
    ds_read_b64_tr_b16 a[86:87], v22 offset:12800
    ds_read_b64_tr_b16 a[156:157], v23 offset:12288
    v_mfma_f32_16x16x32_bf16 v[108:111], v[116:119], a[148:151], v[108:111]
    ds_read_b64_tr_b16 a[158:159], v23 offset:12800
    v_mfma_f32_16x16x32_bf16 v[72:75], v[68:71], v[188:191], v[72:75]
    v_mfma_f32_16x16x32_bf16 v[76:79], v[188:191], v[188:191], v[76:79]
    s_waitcnt vmcnt(30)
    s_waitcnt lgkmcnt(8)
    ds_read_b64_tr_b16 a[224:225], v38 offset:8192
    v_mfma_f32_16x16x32_bf16 v[96:99], v[120:123], v[192:195], v[96:99]
    buffer_load_dwordx4 v[116:119], v4, s[64:67], s10 offen offset:1024 sc1
    ds_read_b64_tr_b16 a[226:227], v38 offset:8704
    ds_read_b64_tr_b16 v[200:201], v20 offset:16384
    v_mfma_f32_16x16x32_bf16 v[100:103], v[120:123], a[8:11], v[100:103]
    ds_read_b64_tr_b16 v[202:203], v20 offset:16896
    ds_read_b64_tr_b16 a[16:17], v21 offset:16384
    ds_read_b64_tr_b16 a[18:19], v21 offset:16896
    v_mfma_f32_16x16x32_bf16 v[104:107], v[120:123], a[80:83], v[104:107]
    ds_read_b64_tr_b16 a[88:89], v22 offset:16384
    ds_read_b64_tr_b16 a[90:91], v22 offset:16896
    ds_read_b64_tr_b16 a[160:161], v23 offset:16384
    v_mfma_f32_16x16x32_bf16 v[108:111], v[120:123], a[152:155], v[108:111]
    ds_read_b64_tr_b16 a[162:163], v23 offset:16896
    v_mfma_f32_16x16x32_bf16 v[72:75], v[68:71], v[192:195], v[72:75]
    v_mfma_f32_16x16x32_bf16 v[76:79], v[192:195], v[192:195], v[76:79]
    s_waitcnt vmcnt(30)
    s_waitcnt lgkmcnt(8)
    ds_read_b64_tr_b16 a[228:229], v38 offset:12288
    v_mfma_f32_16x16x32_bf16 v[96:99], v[124:127], v[196:199], v[96:99]
    buffer_load_dwordx4 v[120:123], v4, s[64:67], s10 offen offset:2048 sc1
    ds_read_b64_tr_b16 a[230:231], v38 offset:12800
    ds_read_b64_tr_b16 v[204:205], v20 offset:20480
    v_mfma_f32_16x16x32_bf16 v[100:103], v[124:127], a[12:15], v[100:103]
    ds_read_b64_tr_b16 v[206:207], v20 offset:20992
    ds_read_b64_tr_b16 a[20:21], v21 offset:20480
    ds_read_b64_tr_b16 a[22:23], v21 offset:20992
    v_mfma_f32_16x16x32_bf16 v[104:107], v[124:127], a[84:87], v[104:107]
    ds_read_b64_tr_b16 a[92:93], v22 offset:20480
    ds_read_b64_tr_b16 a[94:95], v22 offset:20992
    ds_read_b64_tr_b16 a[164:165], v23 offset:20480
    v_mfma_f32_16x16x32_bf16 v[108:111], v[124:127], a[156:159], v[108:111]
    ds_read_b64_tr_b16 a[166:167], v23 offset:20992
    v_mfma_f32_16x16x32_bf16 v[72:75], v[68:71], v[196:199], v[72:75]
    v_mfma_f32_16x16x32_bf16 v[76:79], v[196:199], v[196:199], v[76:79]
    s_waitcnt vmcnt(30)
    s_waitcnt lgkmcnt(8)
    s_waitcnt vmcnt(23)
    s_barrier
    v_mfma_f32_16x16x32_bf16 v[96:99], v[128:131], v[200:203], v[96:99]
    buffer_load_dwordx4 v[124:127], v4, s[64:67], s10 offen offset:3072 sc1
    ds_read_b64_tr_b16 a[232:233], v38 offset:16384
    ds_read_b64_tr_b16 a[234:235], v38 offset:16896
    v_mfma_f32_16x16x32_bf16 v[100:103], v[128:131], a[16:19], v[100:103]
    s_add_u32 s10, s10, 4096
    ds_read_b64_tr_b16 v[208:209], v20 offset:24576
    ds_read_b64_tr_b16 v[210:211], v20 offset:25088
    v_mfma_f32_16x16x32_bf16 v[104:107], v[128:131], a[88:91], v[104:107]
    ds_read_b64_tr_b16 a[24:25], v21 offset:24576
    ds_read_b64_tr_b16 a[26:27], v21 offset:25088
    ds_read_b64_tr_b16 a[96:97], v22 offset:24576
    v_mfma_f32_16x16x32_bf16 v[108:111], v[128:131], a[160:163], v[108:111]
    ds_read_b64_tr_b16 a[98:99], v22 offset:25088
    ds_read_b64_tr_b16 a[168:169], v23 offset:24576
    ds_read_b64_tr_b16 a[170:171], v23 offset:25088
    v_mfma_f32_16x16x32_bf16 v[72:75], v[68:71], v[200:203], v[72:75]
    buffer_store_dwordx4 a[216:219], v4, s[64:67], s49 offen offset:0 sc1
    v_mfma_f32_16x16x32_bf16 v[76:79], v[200:203], v[200:203], v[76:79]
    s_waitcnt vmcnt(30)
    s_waitcnt lgkmcnt(8)
    ds_read_b64_tr_b16 a[236:237], v38 offset:20480
    v_mfma_f32_16x16x32_bf16 v[96:99], v[132:135], v[204:207], v[96:99]
    buffer_load_dwordx4 v[128:131], v4, s[64:67], s10 offen offset:0 sc1
    ds_read_b64_tr_b16 a[238:239], v38 offset:20992
    ds_read_b64_tr_b16 v[212:213], v20 offset:28672
    v_mfma_f32_16x16x32_bf16 v[100:103], v[132:135], a[20:23], v[100:103]
    ds_read_b64_tr_b16 v[214:215], v20 offset:29184
    ds_read_b64_tr_b16 a[28:29], v21 offset:28672
    ds_read_b64_tr_b16 a[30:31], v21 offset:29184
    v_mfma_f32_16x16x32_bf16 v[104:107], v[132:135], a[92:95], v[104:107]
    ds_read_b64_tr_b16 a[100:101], v22 offset:28672
    ds_read_b64_tr_b16 a[102:103], v22 offset:29184
    ds_read_b64_tr_b16 a[172:173], v23 offset:28672
    v_mfma_f32_16x16x32_bf16 v[108:111], v[132:135], a[164:167], v[108:111]
    ds_read_b64_tr_b16 a[174:175], v23 offset:29184
    buffer_store_dwordx4 a[220:223], v4, s[64:67], s49 offen offset:1024 sc1
    v_mfma_f32_16x16x32_bf16 v[72:75], v[68:71], v[204:207], v[72:75]
    v_mfma_f32_16x16x32_bf16 v[76:79], v[204:207], v[204:207], v[76:79]
    s_waitcnt vmcnt(24)
    s_waitcnt lgkmcnt(8)
    ds_read_b64_tr_b16 a[240:241], v38 offset:24576
    v_mfma_f32_16x16x32_bf16 v[96:99], v[136:139], v[208:211], v[96:99]
    buffer_load_dwordx4 v[132:135], v4, s[64:67], s10 offen offset:1024 sc1
    ds_read_b64_tr_b16 a[242:243], v38 offset:25088
    ds_read_b64_tr_b16 v[216:217], v20 offset:32768
    v_mfma_f32_16x16x32_bf16 v[100:103], v[136:139], a[24:27], v[100:103]
    ds_read_b64_tr_b16 v[218:219], v20 offset:33280
    ds_read_b64_tr_b16 a[32:33], v21 offset:32768
    ds_read_b64_tr_b16 a[34:35], v21 offset:33280
    v_mfma_f32_16x16x32_bf16 v[104:107], v[136:139], a[96:99], v[104:107]
    ds_read_b64_tr_b16 a[104:105], v22 offset:32768
    ds_read_b64_tr_b16 a[106:107], v22 offset:33280
    ds_read_b64_tr_b16 a[176:177], v23 offset:32768
    v_mfma_f32_16x16x32_bf16 v[108:111], v[136:139], a[168:171], v[108:111]
    ds_read_b64_tr_b16 a[178:179], v23 offset:33280
    buffer_store_dwordx4 a[224:227], v4, s[64:67], s49 offen offset:2048 sc1
    v_mfma_f32_16x16x32_bf16 v[72:75], v[68:71], v[208:211], v[72:75]
    v_mfma_f32_16x16x32_bf16 v[76:79], v[208:211], v[208:211], v[76:79]
    s_waitcnt vmcnt(24)
    s_waitcnt lgkmcnt(8)
    ds_read_b64_tr_b16 a[244:245], v38 offset:28672
    v_mfma_f32_16x16x32_bf16 v[96:99], v[140:143], v[212:215], v[96:99]
    buffer_load_dwordx4 v[136:139], v4, s[64:67], s10 offen offset:2048 sc1
    ds_read_b64_tr_b16 a[246:247], v38 offset:29184
    ds_read_b64_tr_b16 v[220:221], v20 offset:36864
    v_mfma_f32_16x16x32_bf16 v[100:103], v[140:143], a[28:31], v[100:103]
    ds_read_b64_tr_b16 v[222:223], v20 offset:37376
    ds_read_b64_tr_b16 a[36:37], v21 offset:36864
    ds_read_b64_tr_b16 a[38:39], v21 offset:37376
    v_mfma_f32_16x16x32_bf16 v[104:107], v[140:143], a[100:103], v[104:107]
    ds_read_b64_tr_b16 a[108:109], v22 offset:36864
    ds_read_b64_tr_b16 a[110:111], v22 offset:37376
    ds_read_b64_tr_b16 a[180:181], v23 offset:36864
    v_mfma_f32_16x16x32_bf16 v[108:111], v[140:143], a[172:175], v[108:111]
    ds_read_b64_tr_b16 a[182:183], v23 offset:37376
    buffer_store_dwordx4 a[228:231], v4, s[64:67], s49 offen offset:3072 sc1
    s_add_u32 s49, s49, 4096
    v_mfma_f32_16x16x32_bf16 v[72:75], v[68:71], v[212:215], v[72:75]
    v_mfma_f32_16x16x32_bf16 v[76:79], v[212:215], v[212:215], v[76:79]
    s_waitcnt vmcnt(24)
    s_waitcnt lgkmcnt(8)
    ds_read_b64_tr_b16 a[248:249], v38 offset:32768
    v_mfma_f32_16x16x32_bf16 v[96:99], v[144:147], v[216:219], v[96:99]
    buffer_load_dwordx4 v[140:143], v4, s[64:67], s10 offen offset:3072 sc1
    ds_read_b64_tr_b16 a[250:251], v38 offset:33280
    ds_read_b64_tr_b16 v[224:225], v20 offset:40960
    v_mfma_f32_16x16x32_bf16 v[100:103], v[144:147], a[32:35], v[100:103]
    s_add_u32 s10, s10, 4096
    ds_read_b64_tr_b16 v[226:227], v20 offset:41472
    ds_read_b64_tr_b16 a[40:41], v21 offset:40960
    v_mfma_f32_16x16x32_bf16 v[104:107], v[144:147], a[104:107], v[104:107]
    ds_read_b64_tr_b16 a[42:43], v21 offset:41472
    ds_read_b64_tr_b16 a[112:113], v22 offset:40960
    ds_read_b64_tr_b16 a[114:115], v22 offset:41472
    v_mfma_f32_16x16x32_bf16 v[108:111], v[144:147], a[176:179], v[108:111]
    ds_read_b64_tr_b16 a[184:185], v23 offset:40960
    ds_read_b64_tr_b16 a[186:187], v23 offset:41472
    buffer_store_dwordx4 a[232:235], v4, s[64:67], s49 offen offset:0 sc1
    v_mfma_f32_16x16x32_bf16 v[72:75], v[68:71], v[216:219], v[72:75]
    v_mfma_f32_16x16x32_bf16 v[76:79], v[216:219], v[216:219], v[76:79]
    s_waitcnt vmcnt(24)
    s_waitcnt lgkmcnt(8)
    ds_read_b64_tr_b16 v[228:229], v20 offset:45056
    v_mfma_f32_16x16x32_bf16 v[96:99], v[148:151], v[220:223], v[96:99]
    buffer_load_dwordx4 v[144:147], v4, s[64:67], s10 offen offset:0 sc1
    ds_read_b64_tr_b16 v[230:231], v20 offset:45568
    ds_read_b64_tr_b16 a[44:45], v21 offset:45056
    v_mfma_f32_16x16x32_bf16 v[100:103], v[148:151], a[36:39], v[100:103]
    ds_read_b64_tr_b16 a[46:47], v21 offset:45568
    ds_read_b64_tr_b16 a[116:117], v22 offset:45056
    ds_read_b64_tr_b16 a[118:119], v22 offset:45568
    v_mfma_f32_16x16x32_bf16 v[104:107], v[148:151], a[108:111], v[104:107]
    ds_read_b64_tr_b16 a[188:189], v23 offset:45056
    ds_read_b64_tr_b16 a[190:191], v23 offset:45568
    buffer_store_dwordx4 a[236:239], v4, s[64:67], s49 offen offset:1024 sc1
    v_mfma_f32_16x16x32_bf16 v[108:111], v[148:151], a[180:183], v[108:111]
    v_mfma_f32_16x16x32_bf16 v[72:75], v[68:71], v[220:223], v[72:75]
    v_mfma_f32_16x16x32_bf16 v[76:79], v[220:223], v[220:223], v[76:79]
    s_waitcnt vmcnt(24)
    s_waitcnt lgkmcnt(8)
    s_waitcnt vmcnt(17)
    s_barrier
    v_mfma_f32_16x16x32_bf16 v[96:99], v[152:155], v[224:227], v[96:99]
    buffer_load_dwordx4 v[148:151], v4, s[64:67], s10 offen offset:1024 sc1
    ds_read_b64_tr_b16 v[232:233], v20 offset:49152
    ds_read_b64_tr_b16 v[234:235], v20 offset:49664
    v_mfma_f32_16x16x32_bf16 v[100:103], v[152:155], a[40:43], v[100:103]
    ds_read_b64_tr_b16 a[48:49], v21 offset:49152
    ds_read_b64_tr_b16 a[50:51], v21 offset:49664
    ds_read_b64_tr_b16 a[120:121], v22 offset:49152
    v_mfma_f32_16x16x32_bf16 v[104:107], v[152:155], a[112:115], v[104:107]
    ds_read_b64_tr_b16 a[122:123], v22 offset:49664
    ds_read_b64_tr_b16 a[192:193], v23 offset:49152
    ds_read_b64_tr_b16 a[194:195], v23 offset:49664
    v_mfma_f32_16x16x32_bf16 v[108:111], v[152:155], a[184:187], v[108:111]
    buffer_store_dwordx4 a[240:243], v4, s[64:67], s49 offen offset:2048 sc1
    v_mfma_f32_16x16x32_bf16 v[72:75], v[68:71], v[224:227], v[72:75]
    v_mfma_f32_16x16x32_bf16 v[76:79], v[224:227], v[224:227], v[76:79]
    s_waitcnt vmcnt(24)
    s_waitcnt lgkmcnt(8)
    ds_read_b64_tr_b16 v[236:237], v20 offset:53248
    v_mfma_f32_16x16x32_bf16 v[96:99], v[156:159], v[228:231], v[96:99]
    buffer_load_dwordx4 v[152:155], v4, s[64:67], s10 offen offset:2048 sc1
    ds_read_b64_tr_b16 v[238:239], v20 offset:53760
    ds_read_b64_tr_b16 a[52:53], v21 offset:53248
    v_mfma_f32_16x16x32_bf16 v[100:103], v[156:159], a[44:47], v[100:103]
    ds_read_b64_tr_b16 a[54:55], v21 offset:53760
    ds_read_b64_tr_b16 a[124:125], v22 offset:53248
    ds_read_b64_tr_b16 a[126:127], v22 offset:53760
    v_mfma_f32_16x16x32_bf16 v[104:107], v[156:159], a[116:119], v[104:107]
    ds_read_b64_tr_b16 a[196:197], v23 offset:53248
    ds_read_b64_tr_b16 a[198:199], v23 offset:53760
    buffer_store_dwordx4 a[244:247], v4, s[64:67], s49 offen offset:3072 sc1
    v_mfma_f32_16x16x32_bf16 v[108:111], v[156:159], a[188:191], v[108:111]
    s_add_u32 s49, s49, 4096
    v_mfma_f32_16x16x32_bf16 v[72:75], v[68:71], v[228:231], v[72:75]
    v_mfma_f32_16x16x32_bf16 v[76:79], v[228:231], v[228:231], v[76:79]
    s_waitcnt vmcnt(18)
    s_waitcnt lgkmcnt(8)
    ds_read_b64_tr_b16 v[240:241], v20 offset:57344
    v_mfma_f32_16x16x32_bf16 v[96:99], v[160:163], v[232:235], v[96:99]
    buffer_load_dwordx4 v[156:159], v4, s[64:67], s10 offen offset:3072 sc1
    ds_read_b64_tr_b16 v[242:243], v20 offset:57856
    ds_read_b64_tr_b16 a[56:57], v21 offset:57344
    v_mfma_f32_16x16x32_bf16 v[100:103], v[160:163], a[48:51], v[100:103]
    s_add_u32 s10, s10, 4096
    ds_read_b64_tr_b16 a[58:59], v21 offset:57856
    ds_read_b64_tr_b16 a[128:129], v22 offset:57344
    v_mfma_f32_16x16x32_bf16 v[104:107], v[160:163], a[120:123], v[104:107]
    ds_read_b64_tr_b16 a[130:131], v22 offset:57856
    ds_read_b64_tr_b16 a[200:201], v23 offset:57344
    ds_read_b64_tr_b16 a[202:203], v23 offset:57856
    v_mfma_f32_16x16x32_bf16 v[108:111], v[160:163], a[192:195], v[108:111]
    buffer_store_dwordx4 a[248:251], v4, s[64:67], s49 offen offset:0 sc1
    v_mfma_f32_16x16x32_bf16 v[72:75], v[68:71], v[232:235], v[72:75]
    v_mfma_f32_16x16x32_bf16 v[76:79], v[232:235], v[232:235], v[76:79]
    s_waitcnt vmcnt(18)
    s_waitcnt lgkmcnt(8)
    ds_read_b64_tr_b16 v[244:245], v20 offset:61440
    v_mfma_f32_16x16x32_bf16 v[96:99], v[164:167], v[236:239], v[96:99]
    buffer_load_dwordx4 v[160:163], v4, s[64:67], s10 offen offset:0 sc1
    ds_read_b64_tr_b16 v[246:247], v20 offset:61952
    ds_read_b64_tr_b16 a[60:61], v21 offset:61440
    v_mfma_f32_16x16x32_bf16 v[100:103], v[164:167], a[52:55], v[100:103]
    ds_read_b64_tr_b16 a[62:63], v21 offset:61952
    ds_read_b64_tr_b16 a[132:133], v22 offset:61440
    ds_read_b64_tr_b16 a[134:135], v22 offset:61952
    v_mfma_f32_16x16x32_bf16 v[104:107], v[164:167], a[124:127], v[104:107]
    ds_read_b64_tr_b16 a[204:205], v23 offset:61440
    ds_read_b64_tr_b16 a[206:207], v23 offset:61952
    v_mfma_f32_16x16x32_bf16 v[108:111], v[164:167], a[196:199], v[108:111]
    v_mfma_f32_16x16x32_bf16 v[72:75], v[68:71], v[236:239], v[72:75]
    v_mfma_f32_16x16x32_bf16 v[76:79], v[236:239], v[236:239], v[76:79]
    s_waitcnt vmcnt(18)
    s_waitcnt lgkmcnt(8)
    v_add_u32 v20, 0x10000, v20
    v_mfma_f32_16x16x32_bf16 v[96:99], v[168:171], v[240:243], v[96:99]
    buffer_load_dwordx4 v[164:167], v4, s[64:67], s10 offen offset:1024 sc1
    v_add_u32 v21, 0x10000, v21
    v_add_u32 v22, 0x10000, v22
    v_mfma_f32_16x16x32_bf16 v[100:103], v[168:171], a[56:59], v[100:103]
    v_add_u32 v23, 0x10000, v23
    ds_read_b64_tr_b16 v[248:249], v20 offset:0
    ds_read_b64_tr_b16 v[250:251], v20 offset:512
    v_mfma_f32_16x16x32_bf16 v[104:107], v[168:171], a[128:131], v[104:107]
    ds_read_b64_tr_b16 a[64:65], v21 offset:0
    ds_read_b64_tr_b16 a[66:67], v21 offset:512
    ds_read_b64_tr_b16 a[136:137], v22 offset:0
    v_mfma_f32_16x16x32_bf16 v[108:111], v[168:171], a[200:203], v[108:111]
    ds_read_b64_tr_b16 a[138:139], v22 offset:512
    ds_read_b64_tr_b16 a[208:209], v23 offset:0
    ds_read_b64_tr_b16 a[210:211], v23 offset:512
    v_mfma_f32_16x16x32_bf16 v[72:75], v[68:71], v[240:243], v[72:75]
    v_mfma_f32_16x16x32_bf16 v[76:79], v[240:243], v[240:243], v[76:79]
    s_waitcnt vmcnt(18)
    s_waitcnt lgkmcnt(8)
    ds_read_b64_tr_b16 v[252:253], v20 offset:4096
    v_mfma_f32_16x16x32_bf16 v[96:99], v[172:175], v[244:247], v[96:99]
    buffer_load_dwordx4 v[168:171], v4, s[64:67], s10 offen offset:2048 sc1
    ds_read_b64_tr_b16 v[254:255], v20 offset:4608
    ds_read_b64_tr_b16 a[68:69], v21 offset:4096
    v_mfma_f32_16x16x32_bf16 v[100:103], v[172:175], a[60:63], v[100:103]
    ds_read_b64_tr_b16 a[70:71], v21 offset:4608
    ds_read_b64_tr_b16 a[140:141], v22 offset:4096
    ds_read_b64_tr_b16 a[142:143], v22 offset:4608
    v_mfma_f32_16x16x32_bf16 v[104:107], v[172:175], a[132:135], v[104:107]
    ds_read_b64_tr_b16 a[212:213], v23 offset:4096
    ds_read_b64_tr_b16 a[214:215], v23 offset:4608
    v_mfma_f32_16x16x32_bf16 v[108:111], v[172:175], a[204:207], v[108:111]
    v_mfma_f32_16x16x32_bf16 v[72:75], v[68:71], v[244:247], v[72:75]
    v_mfma_f32_16x16x32_bf16 v[76:79], v[244:247], v[244:247], v[76:79]
    s_waitcnt vmcnt(18)
    s_waitcnt lgkmcnt(8)
    v_mfma_f32_16x16x32_bf16 v[96:99], v[176:179], v[248:251], v[96:99]
    buffer_load_dwordx4 v[172:175], v4, s[64:67], s10 offen offset:3072 sc1
    v_mfma_f32_16x16x32_bf16 v[100:103], v[176:179], a[64:67], v[100:103]
    s_add_u32 s10, s10, 4096
    v_mfma_f32_16x16x32_bf16 v[104:107], v[176:179], a[136:139], v[104:107]
    v_mfma_f32_16x16x32_bf16 v[108:111], v[176:179], a[208:211], v[108:111]
    v_mfma_f32_16x16x32_bf16 v[72:75], v[68:71], v[248:251], v[72:75]
    v_mfma_f32_16x16x32_bf16 v[76:79], v[248:251], v[248:251], v[76:79]
    s_waitcnt vmcnt(16)
    s_waitcnt lgkmcnt(0)
    v_mfma_f32_16x16x32_bf16 v[80:83], v[180:183], v[252:255], v[96:99]
    buffer_load_dwordx4 v[176:179], v4, s[64:67], s10 offen offset:0 sc1
    v_mfma_f32_16x16x32_bf16 v[84:87], v[180:183], a[68:71], v[100:103]
    v_mfma_f32_16x16x32_bf16 v[88:91], v[180:183], a[140:143], v[104:107]
    v_mfma_f32_16x16x32_bf16 v[92:95], v[180:183], a[212:215], v[108:111]
    v_mfma_f32_16x16x32_bf16 v[72:75], v[68:71], v[252:255], v[72:75]
    v_mfma_f32_16x16x32_bf16 v[76:79], v[252:255], v[252:255], v[76:79]
    s_mov_b32 s20, s8
    s_mov_b32 s8, s15
    s_add_u32 s14, s14, 1
    v_and_b32 v8, 3, v5
    v_cmp_eq_u32 vcc, 1, v8
    s_nop 2
    v_cndmask_b32 v37, v76, v77, vcc
    v_cmp_eq_u32 vcc, 2, v8
    s_nop 1
    v_cndmask_b32 v37, v37, v78, vcc
    v_cmp_eq_u32 vcc, 3, v8
    s_nop 1
    v_cndmask_b32 v37, v37, v79, vcc
    v_mul_f32 v36, 0x3ae38e39, v72
    v_mul_f32 v37, 0x3ae38e39, v37
    v_fma_f32 v37, -v36, v36, v37
    v_max_f32 v37, 0, v37
    v_cvt_pk_bf16_f32 v38, v36, v37
    v_lshlrev_b32 v36, 16, v38
    v_and_b32 v37, 0xffff0000, v38
    v_add_f32 v37, 0x3727c5ac, v37
    v_cvt_pk_bf16_f32 v38, v37, v37
    v_and_b32 v37, 0xffff0000, v38
    v_sqrt_f32 v37, v37
    s_nop 0
    v_cvt_pk_bf16_f32 v38, v37, v37
    v_and_b32 v37, 0xffff0000, v38
    v_rcp_f32 v37, v37
    v_lshrrev_b32 v8, 2, v5
    v_cmp_eq_u32 vcc, v8, v6
    s_nop 0
    s_and_saveexec_b64 s[12:13], vcc
    ds_write_b64 v12, v[36:37]
    s_mov_b64 exec, s[12:13]
    s_waitcnt lgkmcnt(0)
    s_barrier
    ds_read_b64 v[52:53], v12
    ds_read_b64 v[54:55], v13
    ds_read_b64 v[56:57], v14
    ds_read_b64 v[58:59], v15
    s_mov_b32 s13, 388
sequential_preLN__ssm_conv_h3__dense_activation_relu__prompt_kernel_ph133:
    s_bitcmp0_b32 s13, s14
    s_cbranch_scc1 sequential_preLN__ssm_conv_h3__dense_activation_relu__prompt_kernel_skip34
    s_cmp_lg_u32 s14, 2
    s_cbranch_scc1 sequential_preLN__ssm_conv_h3__dense_activation_relu__prompt_kernel_skip35
    s_cmp_lt_u32 s2, 112
    s_cbranch_scc1 sequential_preLN__ssm_conv_h3__dense_activation_relu__prompt_kernel_skip36
    s_mov_b64 exec, 0xffff
    buffer_atomic_add v19, v10, s[64:67], s22 offen
    s_mov_b64 exec, -1
sequential_preLN__ssm_conv_h3__dense_activation_relu__prompt_kernel_skip36:
sequential_preLN__ssm_conv_h3__dense_activation_relu__prompt_kernel_skip35:
    s_cmp_lg_u32 s14, 7
    s_cbranch_scc1 sequential_preLN__ssm_conv_h3__dense_activation_relu__prompt_kernel_skip37
    buffer_load_dword v18, v11, s[64:67], s22 offen sc1
sequential_preLN__ssm_conv_h3__dense_activation_relu__prompt_kernel_skip37:
    s_cmp_lg_u32 s14, 8
    s_cbranch_scc1 sequential_preLN__ssm_conv_h3__dense_activation_relu__prompt_kernel_skip38
    s_mov_b32 s12, 400000
    s_waitcnt vmcnt(16)
sequential_preLN__ssm_conv_h3__dense_activation_relu__prompt_kernel_poll39:
    v_cmp_ne_u32 vcc, 144, v18
    s_nop 4
    s_cbranch_vccz sequential_preLN__ssm_conv_h3__dense_activation_relu__prompt_kernel_got40
    s_sub_u32 s12, s12, 1
    s_cmp_eq_u32 s12, 0
    s_cbranch_scc1 sequential_preLN__ssm_conv_h3__dense_activation_relu__prompt_kernel_got40
    s_sleep 2
    buffer_load_dword v18, v11, s[64:67], s22 offen sc1
    s_waitcnt vmcnt(0)
    s_branch sequential_preLN__ssm_conv_h3__dense_activation_relu__prompt_kernel_poll39
sequential_preLN__ssm_conv_h3__dense_activation_relu__prompt_kernel_got40:
sequential_preLN__ssm_conv_h3__dense_activation_relu__prompt_kernel_skip38:
sequential_preLN__ssm_conv_h3__dense_activation_relu__prompt_kernel_skip34:
    s_waitcnt vmcnt(16)
    v_mfma_f32_16x16x32_bf16 v[96:99], v[112:115], v[184:187], 0
    buffer_load_dwordx4 v[180:183], v4, s[64:67], s10 offen offset:1024 sc1
    v_mfma_f32_16x16x32_bf16 v[100:103], v[112:115], a[0:3], 0
    s_add_u32 s15, s8, 1
    s_cmp_eq_u32 s15, 9
    s_cselect_b32 s15, 0, s15
    v_mfma_f32_16x16x32_bf16 v[104:107], v[112:115], a[72:75], 0
    s_cmp_eq_u32 s14, 8
    s_cselect_b32 s12, 5308416, 0
    s_add_u32 s9, s9, s12
    v_mfma_f32_16x16x32_bf16 v[108:111], v[112:115], a[144:147], 0
    s_waitcnt vmcnt(16)
    s_mul_i32 s10, s15, 18432
    s_add_u32 s10, s10, s9
    v_mfma_f32_16x16x32_bf16 v[96:99], v[116:119], v[188:191], v[96:99]
    buffer_load_dwordx4 v[112:115], v4, s[64:67], s10 offen offset:0 sc1
    v_mfma_f32_16x16x32_bf16 v[100:103], v[116:119], a[4:7], v[100:103]
    v_mfma_f32_16x16x32_bf16 v[104:107], v[116:119], a[76:79], v[104:107]
    v_mfma_f32_16x16x32_bf16 v[108:111], v[116:119], a[148:151], v[108:111]
    s_waitcnt vmcnt(16)
    s_lshl_b32 s12, s20, 6
    v_mfma_f32_16x16x32_bf16 v[96:99], v[120:123], v[192:195], v[96:99]
    buffer_load_dwordx4 v[116:119], v4, s[64:67], s10 offen offset:1024 sc1
    v_mfma_f32_16x16x32_bf16 v[100:103], v[120:123], a[8:11], v[100:103]
    v_add_u32 v17, s12, v16
    ds_read_b128 v[60:63], v17
    v_mfma_f32_16x16x32_bf16 v[104:107], v[120:123], a[80:83], v[104:107]
    ds_read_b128 v[64:67], v17 offset:4096
    v_mfma_f32_16x16x32_bf16 v[108:111], v[120:123], a[152:155], v[108:111]
    s_waitcnt vmcnt(16)
    s_lshl_b32 s12, s20, 5
    v_mfma_f32_16x16x32_bf16 v[96:99], v[124:127], v[196:199], v[96:99]
    buffer_load_dwordx4 v[120:123], v4, s[64:67], s10 offen offset:2048 sc1
    v_mfma_f32_16x16x32_bf16 v[100:103], v[124:127], a[12:15], v[100:103]
    v_add_u32 v28, s12, v24
    v_add_u32 v29, s12, v25
    v_mfma_f32_16x16x32_bf16 v[104:107], v[124:127], a[84:87], v[104:107]
    v_add_u32 v30, s12, v26
    v_mfma_f32_16x16x32_bf16 v[108:111], v[124:127], a[156:159], v[108:111]
    s_waitcnt vmcnt(16)
    v_add_u32 v31, s12, v27
    v_mfma_f32_16x16x32_bf16 v[96:99], v[128:131], v[200:203], v[96:99]
    buffer_load_dwordx4 v[124:127], v4, s[64:67], s10 offen offset:3072 sc1
    v_mfma_f32_16x16x32_bf16 v[100:103], v[128:131], a[16:19], v[100:103]
    s_add_u32 s10, s10, 4096
    s_waitcnt lgkmcnt(0)
    v_mfma_f32_16x16x32_bf16 v[104:107], v[128:131], a[88:91], v[104:107]
    v_add_f32 v60, v60, v64
    v_add_f32 v61, v61, v65
    v_mfma_f32_16x16x32_bf16 v[108:111], v[128:131], a[160:163], v[108:111]
    s_waitcnt vmcnt(16)
    v_add_f32 v62, v62, v66
    v_mfma_f32_16x16x32_bf16 v[96:99], v[132:135], v[204:207], v[96:99]
    buffer_load_dwordx4 v[128:131], v4, s[64:67], s10 offen offset:0 sc1
    v_mfma_f32_16x16x32_bf16 v[100:103], v[132:135], a[20:23], v[100:103]
    v_add_f32 v63, v63, v67
    v_fma_f32 v80, -v52, v60, v80
    v_mfma_f32_16x16x32_bf16 v[104:107], v[132:135], a[92:95], v[104:107]
    v_fma_f32 v81, -v52, v61, v81
    v_mfma_f32_16x16x32_bf16 v[108:111], v[132:135], a[164:167], v[108:111]
    s_waitcnt vmcnt(16)
    v_fma_f32 v82, -v52, v62, v82
    v_mfma_f32_16x16x32_bf16 v[96:99], v[136:139], v[208:211], v[96:99]
    buffer_load_dwordx4 v[132:135], v4, s[64:67], s10 offen offset:1024 sc1
    v_mfma_f32_16x16x32_bf16 v[100:103], v[136:139], a[24:27], v[100:103]
    v_fma_f32 v83, -v52, v63, v83
    v_cvt_pk_bf16_f32 v36, v80, v81
    v_mfma_f32_16x16x32_bf16 v[104:107], v[136:139], a[96:99], v[104:107]
    v_cvt_pk_bf16_f32 v37, v82, v83
    v_mfma_f32_16x16x32_bf16 v[108:111], v[136:139], a[168:171], v[108:111]
    s_waitcnt vmcnt(16)
    v_pk_max_i16 v36, v36, 0
    v_mfma_f32_16x16x32_bf16 v[96:99], v[140:143], v[212:215], v[96:99]
    buffer_load_dwordx4 v[136:139], v4, s[64:67], s10 offen offset:2048 sc1
    v_mfma_f32_16x16x32_bf16 v[100:103], v[140:143], a[28:31], v[100:103]
    v_pk_max_i16 v37, v37, 0
    v_mfma_f32_16x16x32_bf16 v[104:107], v[140:143], a[100:103], v[104:107]
    ds_write_b64 v28, v[36:37]
    v_mfma_f32_16x16x32_bf16 v[108:111], v[140:143], a[172:175], v[108:111]
    s_waitcnt vmcnt(16)
    v_fma_f32 v84, -v54, v60, v84
    v_mfma_f32_16x16x32_bf16 v[96:99], v[144:147], v[216:219], v[96:99]
    buffer_load_dwordx4 v[140:143], v4, s[64:67], s10 offen offset:3072 sc1
    v_mfma_f32_16x16x32_bf16 v[100:103], v[144:147], a[32:35], v[100:103]
    s_add_u32 s10, s10, 4096
    v_fma_f32 v85, -v54, v61, v85
    v_mfma_f32_16x16x32_bf16 v[104:107], v[144:147], a[104:107], v[104:107]
    v_fma_f32 v86, -v54, v62, v86
    v_mfma_f32_16x16x32_bf16 v[108:111], v[144:147], a[176:179], v[108:111]
    s_waitcnt vmcnt(16)
    v_fma_f32 v87, -v54, v63, v87
    v_mfma_f32_16x16x32_bf16 v[96:99], v[148:151], v[220:223], v[96:99]
    buffer_load_dwordx4 v[144:147], v4, s[64:67], s10 offen offset:0 sc1
    v_mfma_f32_16x16x32_bf16 v[100:103], v[148:151], a[36:39], v[100:103]
    v_cvt_pk_bf16_f32 v38, v84, v85
    v_mfma_f32_16x16x32_bf16 v[104:107], v[148:151], a[108:111], v[104:107]
    v_cvt_pk_bf16_f32 v39, v86, v87
    v_mfma_f32_16x16x32_bf16 v[108:111], v[148:151], a[180:183], v[108:111]
    s_waitcnt vmcnt(16)
    v_pk_max_i16 v38, v38, 0
    v_mfma_f32_16x16x32_bf16 v[96:99], v[152:155], v[224:227], v[96:99]
    buffer_load_dwordx4 v[148:151], v4, s[64:67], s10 offen offset:1024 sc1
    v_mfma_f32_16x16x32_bf16 v[100:103], v[152:155], a[40:43], v[100:103]
    v_pk_max_i16 v39, v39, 0
    v_mfma_f32_16x16x32_bf16 v[104:107], v[152:155], a[112:115], v[104:107]
    ds_write_b64 v29, v[38:39]
    v_mfma_f32_16x16x32_bf16 v[108:111], v[152:155], a[184:187], v[108:111]
    s_waitcnt vmcnt(16)
    v_fma_f32 v88, -v56, v60, v88
    v_mfma_f32_16x16x32_bf16 v[96:99], v[156:159], v[228:231], v[96:99]
    buffer_load_dwordx4 v[152:155], v4, s[64:67], s10 offen offset:2048 sc1
    v_mfma_f32_16x16x32_bf16 v[100:103], v[156:159], a[44:47], v[100:103]
    v_fma_f32 v89, -v56, v61, v89
    v_mfma_f32_16x16x32_bf16 v[104:107], v[156:159], a[116:119], v[104:107]
    v_fma_f32 v90, -v56, v62, v90
    v_mfma_f32_16x16x32_bf16 v[108:111], v[156:159], a[188:191], v[108:111]
    s_waitcnt vmcnt(16)
    v_fma_f32 v91, -v56, v63, v91
    v_mfma_f32_16x16x32_bf16 v[96:99], v[160:163], v[232:235], v[96:99]
    buffer_load_dwordx4 v[156:159], v4, s[64:67], s10 offen offset:3072 sc1
    v_mfma_f32_16x16x32_bf16 v[100:103], v[160:163], a[48:51], v[100:103]
    s_add_u32 s10, s10, 4096
    v_cvt_pk_bf16_f32 v36, v88, v89
    v_mfma_f32_16x16x32_bf16 v[104:107], v[160:163], a[120:123], v[104:107]
    v_cvt_pk_bf16_f32 v37, v90, v91
    v_mfma_f32_16x16x32_bf16 v[108:111], v[160:163], a[192:195], v[108:111]
    s_waitcnt vmcnt(16)
    v_pk_max_i16 v36, v36, 0
    v_mfma_f32_16x16x32_bf16 v[96:99], v[164:167], v[236:239], v[96:99]
    buffer_load_dwordx4 v[160:163], v4, s[64:67], s10 offen offset:0 sc1
    v_mfma_f32_16x16x32_bf16 v[100:103], v[164:167], a[52:55], v[100:103]
    v_pk_max_i16 v37, v37, 0
    v_mfma_f32_16x16x32_bf16 v[104:107], v[164:167], a[124:127], v[104:107]
    ds_write_b64 v30, v[36:37]
    v_mfma_f32_16x16x32_bf16 v[108:111], v[164:167], a[196:199], v[108:111]
    s_waitcnt vmcnt(16)
    v_fma_f32 v92, -v58, v60, v92
    v_mfma_f32_16x16x32_bf16 v[96:99], v[168:171], v[240:243], v[96:99]
    buffer_load_dwordx4 v[164:167], v4, s[64:67], s10 offen offset:1024 sc1
    v_mfma_f32_16x16x32_bf16 v[100:103], v[168:171], a[56:59], v[100:103]
    v_fma_f32 v93, -v58, v61, v93
    v_mfma_f32_16x16x32_bf16 v[104:107], v[168:171], a[128:131], v[104:107]
    v_fma_f32 v94, -v58, v62, v94
    v_mfma_f32_16x16x32_bf16 v[108:111], v[168:171], a[200:203], v[108:111]
    s_waitcnt vmcnt(16)
    v_fma_f32 v95, -v58, v63, v95
    v_mfma_f32_16x16x32_bf16 v[96:99], v[172:175], v[244:247], v[96:99]
    buffer_load_dwordx4 v[168:171], v4, s[64:67], s10 offen offset:2048 sc1
    v_mfma_f32_16x16x32_bf16 v[100:103], v[172:175], a[60:63], v[100:103]
    v_cvt_pk_bf16_f32 v38, v92, v93
    v_mfma_f32_16x16x32_bf16 v[104:107], v[172:175], a[132:135], v[104:107]
    v_cvt_pk_bf16_f32 v39, v94, v95
    v_mfma_f32_16x16x32_bf16 v[108:111], v[172:175], a[204:207], v[108:111]
    s_waitcnt vmcnt(16)
    v_pk_max_i16 v38, v38, 0
    v_mfma_f32_16x16x32_bf16 v[96:99], v[176:179], v[248:251], v[96:99]
    buffer_load_dwordx4 v[172:175], v4, s[64:67], s10 offen offset:3072 sc1
    v_mfma_f32_16x16x32_bf16 v[100:103], v[176:179], a[64:67], v[100:103]
    s_add_u32 s10, s10, 4096
    v_pk_max_i16 v39, v39, 0
    v_mfma_f32_16x16x32_bf16 v[104:107], v[176:179], a[136:139], v[104:107]
    ds_write_b64 v31, v[38:39]
    v_mfma_f32_16x16x32_bf16 v[108:111], v[176:179], a[208:211], v[108:111]
    s_waitcnt vmcnt(16)
    v_mfma_f32_16x16x32_bf16 v[80:83], v[180:183], v[252:255], v[96:99]
    buffer_load_dwordx4 v[176:179], v4, s[64:67], s10 offen offset:0 sc1
    v_mfma_f32_16x16x32_bf16 v[84:87], v[180:183], a[68:71], v[100:103]
    v_mfma_f32_16x16x32_bf16 v[88:91], v[180:183], a[140:143], v[104:107]
    v_mfma_f32_16x16x32_bf16 v[92:95], v[180:183], a[212:215], v[108:111]
    s_mov_b32 s20, s8
    s_mov_b32 s8, s15
    s_add_u32 s14, s14, 1
    s_cmp_lt_u32 s14, 9
    s_cbranch_scc1 sequential_preLN__ssm_conv_h3__dense_activation_relu__prompt_kernel_ph133
    s_lshl_b32 s12, s20, 6
    v_add_u32 v17, s12, v16
    ds_read_b128 v[60:63], v17
    ds_read_b128 v[64:67], v17 offset:4096
    s_lshl_b32 s12, s20, 5
    v_add_u32 v28, s12, v24
    v_add_u32 v29, s12, v25
    v_add_u32 v30, s12, v26
    v_add_u32 v31, s12, v27
    s_waitcnt lgkmcnt(0)
    v_add_f32 v60, v60, v64
    v_add_f32 v61, v61, v65
    v_add_f32 v62, v62, v66
    v_add_f32 v63, v63, v67
    v_fma_f32 v80, -v52, v60, v80
    v_fma_f32 v81, -v52, v61, v81
    v_fma_f32 v82, -v52, v62, v82
    v_fma_f32 v83, -v52, v63, v83
    v_cvt_pk_bf16_f32 v36, v80, v81
    v_cvt_pk_bf16_f32 v37, v82, v83
    v_pk_max_i16 v36, v36, 0
    v_pk_max_i16 v37, v37, 0
    ds_write_b64 v28, v[36:37]
    v_fma_f32 v84, -v54, v60, v84
    v_fma_f32 v85, -v54, v61, v85
    v_fma_f32 v86, -v54, v62, v86
    v_fma_f32 v87, -v54, v63, v87
    v_cvt_pk_bf16_f32 v38, v84, v85
    v_cvt_pk_bf16_f32 v39, v86, v87
    v_pk_max_i16 v38, v38, 0
    v_pk_max_i16 v39, v39, 0
    ds_write_b64 v29, v[38:39]
    v_fma_f32 v88, -v56, v60, v88
    v_fma_f32 v89, -v56, v61, v89
    v_fma_f32 v90, -v56, v62, v90
    v_fma_f32 v91, -v56, v63, v91
    v_cvt_pk_bf16_f32 v36, v88, v89
    v_cvt_pk_bf16_f32 v37, v90, v91
    v_pk_max_i16 v36, v36, 0
    v_pk_max_i16 v37, v37, 0
    ds_write_b64 v30, v[36:37]
    v_fma_f32 v92, -v58, v60, v92
    v_fma_f32 v93, -v58, v61, v93
    v_fma_f32 v94, -v58, v62, v94
    v_fma_f32 v95, -v58, v63, v95
    v_cvt_pk_bf16_f32 v38, v92, v93
    v_cvt_pk_bf16_f32 v39, v94, v95
    v_pk_max_i16 v38, v38, 0
    v_pk_max_i16 v39, v39, 0
    ds_write_b64 v31, v[38:39]
    s_mul_i32 s12, s5, 288
    v_lshlrev_b32 v8, 3, v6
    v_subrev_u32 v8, s12, v8
    v_add_u32 v24, v8, v24
    v_add_u32 v25, v8, v25
    v_add_u32 v26, v8, v26
    v_add_u32 v27, v8, v27
    s_waitcnt lgkmcnt(0)
    s_barrier
    ds_read_b128 v[184:187], v24 offset:0
    ds_read_b128 a[0:3], v25 offset:0
    ds_read_b128 a[72:75], v26 offset:0
    ds_read_b128 a[144:147], v27 offset:0
    ds_read_b128 v[188:191], v24 offset:64
    ds_read_b128 a[4:7], v25 offset:64
    ds_read_b128 a[76:79], v26 offset:64
    ds_read_b128 a[148:151], v27 offset:64
    ds_read_b128 v[192:195], v24 offset:128
    ds_read_b128 a[8:11], v25 offset:128
    ds_read_b128 a[80:83], v26 offset:128
    ds_read_b128 a[152:155], v27 offset:128
    s_waitcnt vmcnt(16)
    s_waitcnt lgkmcnt(8)
    ds_read_b128 v[196:199], v24 offset:192
    v_mfma_f32_16x16x32_bf16 v[96:99], v[112:115], v[184:187], 0
    buffer_load_dwordx4 v[180:183], v4, s[64:67], s10 offen offset:1024 sc1
    ds_read_b128 a[12:15], v25 offset:192
    ds_read_b128 a[84:87], v26 offset:192
    v_mfma_f32_16x16x32_bf16 v[100:103], v[112:115], a[0:3], 0
    s_add_u32 s15, s8, 1
    s_cmp_eq_u32 s15, 9
    s_cselect_b32 s15, 0, s15
    v_mfma_f32_16x16x32_bf16 v[104:107], v[112:115], a[72:75], 0
    s_mul_i32 s10, s15, 18432
    s_add_u32 s10, s10, s9
    ds_read_b128 a[156:159], v27 offset:192
    v_mfma_f32_16x16x32_bf16 v[108:111], v[112:115], a[144:147], 0
    s_waitcnt vmcnt(16)
    s_waitcnt lgkmcnt(8)
    ds_read_b128 v[200:203], v24 offset:256
    v_mfma_f32_16x16x32_bf16 v[96:99], v[116:119], v[188:191], v[96:99]
    buffer_load_dwordx4 v[112:115], v4, s[64:67], s10 offen offset:0 sc1
    ds_read_b128 a[16:19], v25 offset:256
    ds_read_b128 a[88:91], v26 offset:256
    v_mfma_f32_16x16x32_bf16 v[100:103], v[116:119], a[4:7], v[100:103]
    ds_read_b128 a[160:163], v27 offset:256
    v_mfma_f32_16x16x32_bf16 v[104:107], v[116:119], a[76:79], v[104:107]
    v_mfma_f32_16x16x32_bf16 v[108:111], v[116:119], a[148:151], v[108:111]
    s_waitcnt vmcnt(16)
    s_waitcnt lgkmcnt(8)
    ds_read_b128 v[204:207], v24 offset:320
    v_mfma_f32_16x16x32_bf16 v[96:99], v[120:123], v[192:195], v[96:99]
    buffer_load_dwordx4 v[116:119], v4, s[64:67], s10 offen offset:1024 sc1
    ds_read_b128 a[20:23], v25 offset:320
    ds_read_b128 a[92:95], v26 offset:320
    v_mfma_f32_16x16x32_bf16 v[100:103], v[120:123], a[8:11], v[100:103]
    ds_read_b128 a[164:167], v27 offset:320
    v_mfma_f32_16x16x32_bf16 v[104:107], v[120:123], a[80:83], v[104:107]
    v_mfma_f32_16x16x32_bf16 v[108:111], v[120:123], a[152:155], v[108:111]
    s_waitcnt vmcnt(16)
    s_waitcnt lgkmcnt(8)
    ds_read_b128 v[208:211], v24 offset:384
    v_mfma_f32_16x16x32_bf16 v[96:99], v[124:127], v[196:199], v[96:99]
    buffer_load_dwordx4 v[120:123], v4, s[64:67], s10 offen offset:2048 sc1
    ds_read_b128 a[24:27], v25 offset:384
    ds_read_b128 a[96:99], v26 offset:384
    v_mfma_f32_16x16x32_bf16 v[100:103], v[124:127], a[12:15], v[100:103]
    ds_read_b128 a[168:171], v27 offset:384
    v_mfma_f32_16x16x32_bf16 v[104:107], v[124:127], a[84:87], v[104:107]
    v_mfma_f32_16x16x32_bf16 v[108:111], v[124:127], a[156:159], v[108:111]
    s_waitcnt vmcnt(16)
    s_waitcnt lgkmcnt(8)
    ds_read_b128 v[212:215], v24 offset:448
    v_mfma_f32_16x16x32_bf16 v[96:99], v[128:131], v[200:203], v[96:99]
    buffer_load_dwordx4 v[124:127], v4, s[64:67], s10 offen offset:3072 sc1
    ds_read_b128 a[28:31], v25 offset:448
    ds_read_b128 a[100:103], v26 offset:448
    v_mfma_f32_16x16x32_bf16 v[100:103], v[128:131], a[16:19], v[100:103]
    s_add_u32 s10, s10, 4096
    ds_read_b128 a[172:175], v27 offset:448
    v_mfma_f32_16x16x32_bf16 v[104:107], v[128:131], a[88:91], v[104:107]
    v_mfma_f32_16x16x32_bf16 v[108:111], v[128:131], a[160:163], v[108:111]
    s_waitcnt vmcnt(16)
    s_waitcnt lgkmcnt(8)
    ds_read_b128 v[216:219], v24 offset:512
    v_mfma_f32_16x16x32_bf16 v[96:99], v[132:135], v[204:207], v[96:99]
    buffer_load_dwordx4 v[128:131], v4, s[64:67], s10 offen offset:0 sc1
    ds_read_b128 a[32:35], v25 offset:512
    ds_read_b128 a[104:107], v26 offset:512
    v_mfma_f32_16x16x32_bf16 v[100:103], v[132:135], a[20:23], v[100:103]
    ds_read_b128 a[176:179], v27 offset:512
    v_mfma_f32_16x16x32_bf16 v[104:107], v[132:135], a[92:95], v[104:107]
    v_mfma_f32_16x16x32_bf16 v[108:111], v[132:135], a[164:167], v[108:111]
    s_waitcnt vmcnt(16)
    s_waitcnt lgkmcnt(8)
    ds_read_b128 v[220:223], v24 offset:576
    v_mfma_f32_16x16x32_bf16 v[96:99], v[136:139], v[208:211], v[96:99]
    buffer_load_dwordx4 v[132:135], v4, s[64:67], s10 offen offset:1024 sc1
    ds_read_b128 a[36:39], v25 offset:576
    ds_read_b128 a[108:111], v26 offset:576
    v_mfma_f32_16x16x32_bf16 v[100:103], v[136:139], a[24:27], v[100:103]
    ds_read_b128 a[180:183], v27 offset:576
    v_mfma_f32_16x16x32_bf16 v[104:107], v[136:139], a[96:99], v[104:107]
    v_mfma_f32_16x16x32_bf16 v[108:111], v[136:139], a[168:171], v[108:111]
    s_waitcnt vmcnt(16)
    s_waitcnt lgkmcnt(8)
    ds_read_b128 v[224:227], v24 offset:640
    v_mfma_f32_16x16x32_bf16 v[96:99], v[140:143], v[212:215], v[96:99]
    buffer_load_dwordx4 v[136:139], v4, s[64:67], s10 offen offset:2048 sc1
    ds_read_b128 a[40:43], v25 offset:640
    ds_read_b128 a[112:115], v26 offset:640
    v_mfma_f32_16x16x32_bf16 v[100:103], v[140:143], a[28:31], v[100:103]
    ds_read_b128 a[184:187], v27 offset:640
    v_mfma_f32_16x16x32_bf16 v[104:107], v[140:143], a[100:103], v[104:107]
    v_mfma_f32_16x16x32_bf16 v[108:111], v[140:143], a[172:175], v[108:111]
    s_waitcnt vmcnt(16)
    s_waitcnt lgkmcnt(8)
    ds_read_b128 v[228:231], v24 offset:704
    v_mfma_f32_16x16x32_bf16 v[96:99], v[144:147], v[216:219], v[96:99]
    buffer_load_dwordx4 v[140:143], v4, s[64:67], s10 offen offset:3072 sc1
    ds_read_b128 a[44:47], v25 offset:704
    ds_read_b128 a[116:119], v26 offset:704
    v_mfma_f32_16x16x32_bf16 v[100:103], v[144:147], a[32:35], v[100:103]
    s_add_u32 s10, s10, 4096
    ds_read_b128 a[188:191], v27 offset:704
    v_mfma_f32_16x16x32_bf16 v[104:107], v[144:147], a[104:107], v[104:107]
    v_mfma_f32_16x16x32_bf16 v[108:111], v[144:147], a[176:179], v[108:111]
    s_waitcnt vmcnt(16)
    s_waitcnt lgkmcnt(8)
    ds_read_b128 v[232:235], v24 offset:768
    v_mfma_f32_16x16x32_bf16 v[96:99], v[148:151], v[220:223], v[96:99]
    buffer_load_dwordx4 v[144:147], v4, s[64:67], s10 offen offset:0 sc1
    ds_read_b128 a[48:51], v25 offset:768
    ds_read_b128 a[120:123], v26 offset:768
    v_mfma_f32_16x16x32_bf16 v[100:103], v[148:151], a[36:39], v[100:103]
    ds_read_b128 a[192:195], v27 offset:768
    v_mfma_f32_16x16x32_bf16 v[104:107], v[148:151], a[108:111], v[104:107]
    v_mfma_f32_16x16x32_bf16 v[108:111], v[148:151], a[180:183], v[108:111]
    s_waitcnt vmcnt(16)
    s_waitcnt lgkmcnt(8)
    ds_read_b128 v[236:239], v24 offset:832
    v_mfma_f32_16x16x32_bf16 v[96:99], v[152:155], v[224:227], v[96:99]
    buffer_load_dwordx4 v[148:151], v4, s[64:67], s10 offen offset:1024 sc1
    ds_read_b128 a[52:55], v25 offset:832
    ds_read_b128 a[124:127], v26 offset:832
    v_mfma_f32_16x16x32_bf16 v[100:103], v[152:155], a[40:43], v[100:103]
    ds_read_b128 a[196:199], v27 offset:832
    v_mfma_f32_16x16x32_bf16 v[104:107], v[152:155], a[112:115], v[104:107]
    v_mfma_f32_16x16x32_bf16 v[108:111], v[152:155], a[184:187], v[108:111]
    s_waitcnt vmcnt(16)
    s_waitcnt lgkmcnt(8)
    ds_read_b128 v[240:243], v24 offset:896
    v_mfma_f32_16x16x32_bf16 v[96:99], v[156:159], v[228:231], v[96:99]
    buffer_load_dwordx4 v[152:155], v4, s[64:67], s10 offen offset:2048 sc1
    ds_read_b128 a[56:59], v25 offset:896
    ds_read_b128 a[128:131], v26 offset:896
    v_mfma_f32_16x16x32_bf16 v[100:103], v[156:159], a[44:47], v[100:103]
    ds_read_b128 a[200:203], v27 offset:896
    v_mfma_f32_16x16x32_bf16 v[104:107], v[156:159], a[116:119], v[104:107]
    v_mfma_f32_16x16x32_bf16 v[108:111], v[156:159], a[188:191], v[108:111]
    s_waitcnt vmcnt(16)
    s_waitcnt lgkmcnt(8)
    ds_read_b128 v[244:247], v24 offset:960
    v_mfma_f32_16x16x32_bf16 v[96:99], v[160:163], v[232:235], v[96:99]
    buffer_load_dwordx4 v[156:159], v4, s[64:67], s10 offen offset:3072 sc1
    ds_read_b128 a[60:63], v25 offset:960
    ds_read_b128 a[132:135], v26 offset:960
    v_mfma_f32_16x16x32_bf16 v[100:103], v[160:163], a[48:51], v[100:103]
    s_add_u32 s10, s10, 4096
    ds_read_b128 a[204:207], v27 offset:960
    v_mfma_f32_16x16x32_bf16 v[104:107], v[160:163], a[120:123], v[104:107]
    v_mfma_f32_16x16x32_bf16 v[108:111], v[160:163], a[192:195], v[108:111]
    s_waitcnt vmcnt(16)
    s_waitcnt lgkmcnt(8)
    ds_read_b128 v[248:251], v24 offset:1024
    v_mfma_f32_16x16x32_bf16 v[96:99], v[164:167], v[236:239], v[96:99]
    buffer_load_dwordx4 v[160:163], v4, s[64:67], s10 offen offset:0 sc1
    ds_read_b128 a[64:67], v25 offset:1024
    ds_read_b128 a[136:139], v26 offset:1024
    v_mfma_f32_16x16x32_bf16 v[100:103], v[164:167], a[52:55], v[100:103]
    ds_read_b128 a[208:211], v27 offset:1024
    v_mfma_f32_16x16x32_bf16 v[104:107], v[164:167], a[124:127], v[104:107]
    v_mfma_f32_16x16x32_bf16 v[108:111], v[164:167], a[196:199], v[108:111]
    s_waitcnt vmcnt(16)
    s_waitcnt lgkmcnt(8)
    ds_read_b128 v[252:255], v24 offset:1088
    v_mfma_f32_16x16x32_bf16 v[96:99], v[168:171], v[240:243], v[96:99]
    buffer_load_dwordx4 v[164:167], v4, s[64:67], s10 offen offset:1024 sc1
    ds_read_b128 a[68:71], v25 offset:1088
    ds_read_b128 a[140:143], v26 offset:1088
    v_mfma_f32_16x16x32_bf16 v[100:103], v[168:171], a[56:59], v[100:103]
    ds_read_b128 a[212:215], v27 offset:1088
    v_mfma_f32_16x16x32_bf16 v[104:107], v[168:171], a[128:131], v[104:107]
    v_mfma_f32_16x16x32_bf16 v[108:111], v[168:171], a[200:203], v[108:111]
    s_waitcnt vmcnt(16)
    s_waitcnt lgkmcnt(8)
    v_mfma_f32_16x16x32_bf16 v[96:99], v[172:175], v[244:247], v[96:99]
    buffer_load_dwordx4 v[168:171], v4, s[64:67], s10 offen offset:2048 sc1
    v_mfma_f32_16x16x32_bf16 v[100:103], v[172:175], a[60:63], v[100:103]
    v_mfma_f32_16x16x32_bf16 v[104:107], v[172:175], a[132:135], v[104:107]
    v_mfma_f32_16x16x32_bf16 v[108:111], v[172:175], a[204:207], v[108:111]
    s_waitcnt vmcnt(16)
    s_waitcnt lgkmcnt(4)
    v_mfma_f32_16x16x32_bf16 v[96:99], v[176:179], v[248:251], v[96:99]
    buffer_load_dwordx4 v[172:175], v4, s[64:67], s10 offen offset:3072 sc1
    v_mfma_f32_16x16x32_bf16 v[100:103], v[176:179], a[64:67], v[100:103]
    s_add_u32 s10, s10, 4096
    v_mfma_f32_16x16x32_bf16 v[104:107], v[176:179], a[136:139], v[104:107]
    v_mfma_f32_16x16x32_bf16 v[108:111], v[176:179], a[208:211], v[108:111]
    s_waitcnt vmcnt(16)
    s_waitcnt lgkmcnt(0)
    v_mfma_f32_16x16x32_bf16 v[80:83], v[180:183], v[252:255], v[96:99]
    buffer_load_dwordx4 v[176:179], v4, s[64:67], s10 offen offset:0 sc1
    v_mfma_f32_16x16x32_bf16 v[84:87], v[180:183], a[68:71], v[100:103]
    v_mfma_f32_16x16x32_bf16 v[88:91], v[180:183], a[140:143], v[104:107]
    v_mfma_f32_16x16x32_bf16 v[92:95], v[180:183], a[212:215], v[108:111]
    s_mov_b32 s20, s8
    s_mov_b32 s8, s15
    s_add_u32 s14, s14, 1
    s_mov_b32 s21, 0x7f000000
    buffer_store_dwordx2 v[36:37], v32, s[64:67], s21 offen
    buffer_store_dwordx2 v[36:37], v33, s[64:67], s21 offen
    buffer_store_dwordx2 v[36:37], v34, s[64:67], s21 offen
    buffer_store_dwordx2 v[36:37], v35, s[64:67], s21 offen
sequential_preLN__ssm_conv_h3__dense_activation_relu__prompt_kernel_ph241:
    s_waitcnt vmcnt(20)
    v_mfma_f32_16x16x32_bf16 v[96:99], v[112:115], v[184:187], 0
    buffer_load_dwordx4 v[180:183], v4, s[64:67], s10 offen offset:1024 sc1
    v_mfma_f32_16x16x32_bf16 v[100:103], v[112:115], a[0:3], 0
    s_add_u32 s15, s8, 1
    s_cmp_eq_u32 s15, 9
    s_cselect_b32 s15, 0, s15
    v_mfma_f32_16x16x32_bf16 v[104:107], v[112:115], a[72:75], 0
    s_mul_i32 s10, s15, 18432
    s_add_u32 s10, s10, s9
    s_cmp_eq_u32 s14, 17
    v_mfma_f32_16x16x32_bf16 v[108:111], v[112:115], a[144:147], 0
    s_waitcnt vmcnt(20)
    s_cselect_b32 s10, 0x7f000000, s10
    v_mfma_f32_16x16x32_bf16 v[96:99], v[116:119], v[188:191], v[96:99]
    buffer_load_dwordx4 v[112:115], v4, s[64:67], s10 offen offset:0 sc1
    v_mfma_f32_16x16x32_bf16 v[100:103], v[116:119], a[4:7], v[100:103]
    v_mfma_f32_16x16x32_bf16 v[104:107], v[116:119], a[76:79], v[104:107]
    v_mfma_f32_16x16x32_bf16 v[108:111], v[116:119], a[148:151], v[108:111]
    s_waitcnt vmcnt(20)
    s_lshr_b32 s12, s20, 1
    v_mfma_f32_16x16x32_bf16 v[96:99], v[120:123], v[192:195], v[96:99]
    buffer_load_dwordx4 v[116:119], v4, s[64:67], s10 offen offset:1024 sc1
    v_mfma_f32_16x16x32_bf16 v[100:103], v[120:123], a[8:11], v[100:103]
    s_lshl_b32 s12, s12, 12
    v_mfma_f32_16x16x32_bf16 v[104:107], v[120:123], a[80:83], v[104:107]
    s_add_u32 s12, s12, s18
    v_mfma_f32_16x16x32_bf16 v[108:111], v[120:123], a[152:155], v[108:111]
    s_waitcnt vmcnt(20)
    s_cmp_eq_u32 s20, 8
    s_cselect_b32 s12, s17, s12
    v_mfma_f32_16x16x32_bf16 v[96:99], v[124:127], v[196:199], v[96:99]
    buffer_load_dwordx4 v[120:123], v4, s[64:67], s10 offen offset:2048 sc1
    v_mfma_f32_16x16x32_bf16 v[100:103], v[124:127], a[12:15], v[100:103]
    s_add_u32 s21, s12, s16
    v_mfma_f32_16x16x32_bf16 v[104:107], v[124:127], a[84:87], v[104:107]
    s_and_b32 s13, s20, 9
    v_mfma_f32_16x16x32_bf16 v[108:111], v[124:127], a[156:159], v[108:111]
    s_waitcnt vmcnt(20)
    s_cmp_eq_u32 s13, 0
    s_cselect_b32 s21, 0x7f000000, s21
    v_mfma_f32_16x16x32_bf16 v[96:99], v[128:131], v[200:203], v[96:99]
    buffer_load_dwordx4 v[124:127], v4, s[64:67], s10 offen offset:3072 sc1
    v_mfma_f32_16x16x32_bf16 v[100:103], v[128:131], a[16:19], v[100:103]
    s_add_u32 s10, s10, 4096
    v_mul_f32 v80, v53, v80
    v_mfma_f32_16x16x32_bf16 v[104:107], v[128:131], a[88:91], v[104:107]
    v_mul_f32 v81, v53, v81
    v_mfma_f32_16x16x32_bf16 v[108:111], v[128:131], a[160:163], v[108:111]
    s_waitcnt vmcnt(20)
    v_mul_f32 v82, v53, v82
    v_mfma_f32_16x16x32_bf16 v[96:99], v[132:135], v[204:207], v[96:99]
    buffer_load_dwordx4 v[128:131], v4, s[64:67], s10 offen offset:0 sc1
    v_mfma_f32_16x16x32_bf16 v[100:103], v[132:135], a[20:23], v[100:103]
    v_mul_f32 v83, v53, v83
    v_mfma_f32_16x16x32_bf16 v[104:107], v[132:135], a[92:95], v[104:107]
    v_mov_b32 v36, v38
    v_mfma_f32_16x16x32_bf16 v[108:111], v[132:135], a[164:167], v[108:111]
    s_waitcnt vmcnt(19)
    v_mov_b32 v37, v39
    v_mfma_f32_16x16x32_bf16 v[96:99], v[136:139], v[208:211], v[96:99]
    buffer_load_dwordx4 v[132:135], v4, s[64:67], s10 offen offset:1024 sc1
    v_mfma_f32_16x16x32_bf16 v[100:103], v[136:139], a[24:27], v[100:103]
    v_cvt_pk_bf16_f32 v38, v80, v81
    v_mfma_f32_16x16x32_bf16 v[104:107], v[136:139], a[96:99], v[104:107]
    v_cvt_pk_bf16_f32 v39, v82, v83
    v_mfma_f32_16x16x32_bf16 v[108:111], v[136:139], a[168:171], v[108:111]
    s_waitcnt vmcnt(19)
    buffer_store_dwordx4 v[36:39], v32, s[64:67], s21 offen sc1
    v_mfma_f32_16x16x32_bf16 v[96:99], v[140:143], v[212:215], v[96:99]
    buffer_load_dwordx4 v[136:139], v4, s[64:67], s10 offen offset:2048 sc1
    v_mfma_f32_16x16x32_bf16 v[100:103], v[140:143], a[28:31], v[100:103]
    v_mul_f32 v84, v55, v84
    v_mfma_f32_16x16x32_bf16 v[104:107], v[140:143], a[100:103], v[104:107]
    v_mul_f32 v85, v55, v85
    v_mfma_f32_16x16x32_bf16 v[108:111], v[140:143], a[172:175], v[108:111]
    s_waitcnt vmcnt(20)
    v_mul_f32 v86, v55, v86
    v_mfma_f32_16x16x32_bf16 v[96:99], v[144:147], v[216:219], v[96:99]
    buffer_load_dwordx4 v[140:143], v4, s[64:67], s10 offen offset:3072 sc1
    v_mfma_f32_16x16x32_bf16 v[100:103], v[144:147], a[32:35], v[100:103]
    s_add_u32 s10, s10, 4096
    v_mul_f32 v87, v55, v87
    v_mfma_f32_16x16x32_bf16 v[104:107], v[144:147], a[104:107], v[104:107]
    v_mov_b32 v40, v42
    v_mfma_f32_16x16x32_bf16 v[108:111], v[144:147], a[176:179], v[108:111]
    s_waitcnt vmcnt(19)
    v_mov_b32 v41, v43
    v_mfma_f32_16x16x32_bf16 v[96:99], v[148:151], v[220:223], v[96:99]
    buffer_load_dwordx4 v[144:147], v4, s[64:67], s10 offen offset:0 sc1
    v_mfma_f32_16x16x32_bf16 v[100:103], v[148:151], a[36:39], v[100:103]
    v_cvt_pk_bf16_f32 v42, v84, v85
    v_mfma_f32_16x16x32_bf16 v[104:107], v[148:151], a[108:111], v[104:107]
    v_cvt_pk_bf16_f32 v43, v86, v87
    v_mfma_f32_16x16x32_bf16 v[108:111], v[148:151], a[180:183], v[108:111]
    s_waitcnt vmcnt(19)
    buffer_store_dwordx4 v[40:43], v33, s[64:67], s21 offen sc1
    v_mfma_f32_16x16x32_bf16 v[96:99], v[152:155], v[224:227], v[96:99]
    buffer_load_dwordx4 v[148:151], v4, s[64:67], s10 offen offset:1024 sc1
    v_mfma_f32_16x16x32_bf16 v[100:103], v[152:155], a[40:43], v[100:103]
    v_mul_f32 v88, v57, v88
    v_mfma_f32_16x16x32_bf16 v[104:107], v[152:155], a[112:115], v[104:107]
    v_mul_f32 v89, v57, v89
    v_mfma_f32_16x16x32_bf16 v[108:111], v[152:155], a[184:187], v[108:111]
    s_waitcnt vmcnt(20)
    v_mul_f32 v90, v57, v90
    v_mfma_f32_16x16x32_bf16 v[96:99], v[156:159], v[228:231], v[96:99]
    buffer_load_dwordx4 v[152:155], v4, s[64:67], s10 offen offset:2048 sc1
    v_mfma_f32_16x16x32_bf16 v[100:103], v[156:159], a[44:47], v[100:103]
    v_mul_f32 v91, v57, v91
    v_mfma_f32_16x16x32_bf16 v[104:107], v[156:159], a[116:119], v[104:107]
    v_mov_b32 v44, v46
    v_mfma_f32_16x16x32_bf16 v[108:111], v[156:159], a[188:191], v[108:111]
    s_waitcnt vmcnt(19)
    v_mov_b32 v45, v47
    v_mfma_f32_16x16x32_bf16 v[96:99], v[160:163], v[232:235], v[96:99]
    buffer_load_dwordx4 v[156:159], v4, s[64:67], s10 offen offset:3072 sc1
    v_mfma_f32_16x16x32_bf16 v[100:103], v[160:163], a[48:51], v[100:103]
    s_add_u32 s10, s10, 4096
    v_cvt_pk_bf16_f32 v46, v88, v89
    v_mfma_f32_16x16x32_bf16 v[104:107], v[160:163], a[120:123], v[104:107]
    v_cvt_pk_bf16_f32 v47, v90, v91
    v_mfma_f32_16x16x32_bf16 v[108:111], v[160:163], a[192:195], v[108:111]
    s_waitcnt vmcnt(19)
    buffer_store_dwordx4 v[44:47], v34, s[64:67], s21 offen sc1
    v_mfma_f32_16x16x32_bf16 v[96:99], v[164:167], v[236:239], v[96:99]
    buffer_load_dwordx4 v[160:163], v4, s[64:67], s10 offen offset:0 sc1
    v_mfma_f32_16x16x32_bf16 v[100:103], v[164:167], a[52:55], v[100:103]
    v_mul_f32 v92, v59, v92
    v_mfma_f32_16x16x32_bf16 v[104:107], v[164:167], a[124:127], v[104:107]
    v_mul_f32 v93, v59, v93
    v_mfma_f32_16x16x32_bf16 v[108:111], v[164:167], a[196:199], v[108:111]
    s_waitcnt vmcnt(20)
    v_mul_f32 v94, v59, v94
    v_mfma_f32_16x16x32_bf16 v[96:99], v[168:171], v[240:243], v[96:99]
    buffer_load_dwordx4 v[164:167], v4, s[64:67], s10 offen offset:1024 sc1
    v_mfma_f32_16x16x32_bf16 v[100:103], v[168:171], a[56:59], v[100:103]
    v_mul_f32 v95, v59, v95
    v_mfma_f32_16x16x32_bf16 v[104:107], v[168:171], a[128:131], v[104:107]
    v_mov_b32 v48, v50
    v_mfma_f32_16x16x32_bf16 v[108:111], v[168:171], a[200:203], v[108:111]
    s_waitcnt vmcnt(20)
    v_mfma_f32_16x16x32_bf16 v[96:99], v[172:175], v[244:247], v[96:99]
    buffer_load_dwordx4 v[168:171], v4, s[64:67], s10 offen offset:2048 sc1
    v_mfma_f32_16x16x32_bf16 v[100:103], v[172:175], a[60:63], v[100:103]
    v_mov_b32 v49, v51
    v_mfma_f32_16x16x32_bf16 v[104:107], v[172:175], a[132:135], v[104:107]
    v_cvt_pk_bf16_f32 v50, v92, v93
    v_mfma_f32_16x16x32_bf16 v[108:111], v[172:175], a[204:207], v[108:111]
    s_waitcnt vmcnt(19)
    v_mfma_f32_16x16x32_bf16 v[96:99], v[176:179], v[248:251], v[96:99]
    buffer_load_dwordx4 v[172:175], v4, s[64:67], s10 offen offset:3072 sc1
    v_mfma_f32_16x16x32_bf16 v[100:103], v[176:179], a[64:67], v[100:103]
    s_add_u32 s10, s10, 4096
    v_cvt_pk_bf16_f32 v51, v94, v95
    v_mfma_f32_16x16x32_bf16 v[104:107], v[176:179], a[136:139], v[104:107]
    buffer_store_dwordx4 v[48:51], v35, s[64:67], s21 offen sc1
    v_mfma_f32_16x16x32_bf16 v[108:111], v[176:179], a[208:211], v[108:111]
    s_waitcnt vmcnt(20)
    v_mfma_f32_16x16x32_bf16 v[80:83], v[180:183], v[252:255], v[96:99]
    buffer_load_dwordx4 v[176:179], v4, s[64:67], s10 offen offset:0 sc1
    v_mfma_f32_16x16x32_bf16 v[84:87], v[180:183], a[68:71], v[100:103]
    v_mfma_f32_16x16x32_bf16 v[88:91], v[180:183], a[140:143], v[104:107]
    v_mfma_f32_16x16x32_bf16 v[92:95], v[180:183], a[212:215], v[108:111]
    s_mov_b32 s20, s8
    s_mov_b32 s8, s15
    s_add_u32 s14, s14, 1
    s_cmp_lt_u32 s14, 18
    s_cbranch_scc1 sequential_preLN__ssm_conv_h3__dense_activation_relu__prompt_kernel_ph241
    s_lshr_b32 s12, s20, 1
    s_lshl_b32 s12, s12, 12
    s_add_u32 s12, s12, s18
    s_cmp_eq_u32 s20, 8
    s_cselect_b32 s12, s17, s12
    s_add_u32 s21, s12, s16
    s_and_b32 s13, s20, 9
    s_cmp_eq_u32 s13, 0
    s_cselect_b32 s21, 0x7f000000, s21
    v_mul_f32 v80, v53, v80
    v_mul_f32 v81, v53, v81
    v_mul_f32 v82, v53, v82
    v_mul_f32 v83, v53, v83
    v_mov_b32 v36, v38
    v_mov_b32 v37, v39
    v_cvt_pk_bf16_f32 v38, v80, v81
    v_cvt_pk_bf16_f32 v39, v82, v83
    buffer_store_dwordx4 v[36:39], v32, s[64:67], s21 offen sc1
    v_mul_f32 v84, v55, v84
    v_mul_f32 v85, v55, v85
    v_mul_f32 v86, v55, v86
    v_mul_f32 v87, v55, v87
    v_mov_b32 v40, v42
    v_mov_b32 v41, v43
    v_cvt_pk_bf16_f32 v42, v84, v85
    v_cvt_pk_bf16_f32 v43, v86, v87
    buffer_store_dwordx4 v[40:43], v33, s[64:67], s21 offen sc1
    v_mul_f32 v88, v57, v88
    v_mul_f32 v89, v57, v89
    v_mul_f32 v90, v57, v90
    v_mul_f32 v91, v57, v91
    v_mov_b32 v44, v46
    v_mov_b32 v45, v47
    v_cvt_pk_bf16_f32 v46, v88, v89
    v_cvt_pk_bf16_f32 v47, v90, v91
    buffer_store_dwordx4 v[44:47], v34, s[64:67], s21 offen sc1
    v_mul_f32 v92, v59, v92
    v_mul_f32 v93, v59, v93
    v_mul_f32 v94, v59, v94
    v_mul_f32 v95, v59, v95
    v_mov_b32 v48, v50
    v_mov_b32 v49, v51
    v_cvt_pk_bf16_f32 v50, v92, v93
    v_cvt_pk_bf16_f32 v51, v94, v95
    buffer_store_dwordx4 v[48:51], v35, s[64:67], s21 offen sc1
    s_lshl_b32 s12, s3, 3
    s_lshl_b32 s13, s5, 1
    s_add_u32 s12, s12, s13
    s_lshr_b32 s13, s12, 2
    s_and_b32 s15, s12, 3
    s_lshl_b32 s20, s13, 12
    s_add_u32 s21, s15, 0
    v_xor_b32 v8, s21, v7
    v_lshl_add_u32 v8, v8, 5, v9
    v_add_u32 v8, s20, v8
    ds_read_b64_tr_b16 v[20:21], v8
    ds_read_b64_tr_b16 v[22:23], v8 offset:512
    s_add_u32 s21, s15, 1
    v_xor_b32 v8, s21, v7
    v_lshl_add_u32 v8, v8, 5, v9
    v_add_u32 v8, s20, v8
    ds_read_b64_tr_b16 v[24:25], v8
    ds_read_b64_tr_b16 v[26:27], v8 offset:512
    s_lshr_b32 s22, s3, 2
    s_add_u32 s22, s22, 16
    s_and_b32 s23, s3, 3
    v_xor_b32 v8, s23, v7
    v_lshl_add_u32 v8, v8, 5, v9
    s_lshl_b32 s21, s22, 12
    v_add_u32 v8, s21, v8
    ds_read_b64_tr_b16 v[28:29], v8
    ds_read_b64_tr_b16 v[30:31], v8 offset:512
    v_mul_u32_u24 v10, 1152, v5
    v_lshl_add_u32 v10, v6, 4, v10
    s_mul_i32 s24, s4, 73728
    s_mul_i32 s25, s15, 18432
    s_lshl_b32 s26, s13, 6
    s_add_u32 s25, s25, s26
    s_add_u32 s25, s25, s24
    s_mul_i32 s26, s23, 18432
    s_lshl_b32 s27, s22, 6
    s_add_u32 s26, s26, s27
    s_add_u32 s26, s26, s24
    s_lshl_b32 s27, s12, 10
    s_add_u32 s27, s27, s19
    s_lshr_b32 s28, s3, 2
    s_lshl_b32 s28, s28, 13
    s_lshl_b32 s29, s23, 10
    s_add_u32 s28, s28, s29
    s_add_u32 s28, s28, s19
    s_add_u32 s28, s28, 65536
    s_lshl_b32 s29, s4, 7
    s_add_u32 s29, s29, 10321920
    v_mov_b32 v36, 0
    s_waitcnt vmcnt(0)
    s_barrier
    s_cmp_lg_u32 s5, 0
    s_cbranch_scc1 sequential_preLN__ssm_conv_h3__dense_activation_relu__prompt_kernel_skip42
    s_mov_b64 exec, 1
    buffer_atomic_add v19, v36, s[64:67], s29 offen
    s_mov_b32 s12, 400000
    buffer_load_dword v18, v36, s[64:67], s29 offen sc1
    s_waitcnt vmcnt(0)
sequential_preLN__ssm_conv_h3__dense_activation_relu__prompt_kernel_poll43:
    v_cmp_ne_u32 vcc, 8, v18
    s_nop 4
    s_cbranch_vccz sequential_preLN__ssm_conv_h3__dense_activation_relu__prompt_kernel_got44
    s_sub_u32 s12, s12, 1
    s_cmp_eq_u32 s12, 0
    s_cbranch_scc1 sequential_preLN__ssm_conv_h3__dense_activation_relu__prompt_kernel_got44
    s_sleep 2
    buffer_load_dword v18, v36, s[64:67], s29 offen sc1
    s_waitcnt vmcnt(0)
    s_branch sequential_preLN__ssm_conv_h3__dense_activation_relu__prompt_kernel_poll43
sequential_preLN__ssm_conv_h3__dense_activation_relu__prompt_kernel_got44:
    s_mov_b64 exec, -1
sequential_preLN__ssm_conv_h3__dense_activation_relu__prompt_kernel_skip42:
    s_barrier
    buffer_load_dwordx4 v[112:115], v4, s[64:67], s27 offen offset:0 sc1
    buffer_load_dwordx4 v[144:147], v4, s[64:67], s27 offen offset:1024 sc1
    s_add_u32 s27, s27, 2621440
    buffer_load_dwordx4 v[116:119], v4, s[64:67], s27 offen offset:0 sc1
    buffer_load_dwordx4 v[148:151], v4, s[64:67], s27 offen offset:1024 sc1
    s_add_u32 s27, s27, 2621440
    buffer_load_dwordx4 v[120:123], v4, s[64:67], s27 offen offset:0 sc1
    buffer_load_dwordx4 v[152:155], v4, s[64:67], s27 offen offset:1024 sc1
    s_add_u32 s27, s27, 2621440
    buffer_load_dwordx4 v[124:127], v4, s[64:67], s27 offen offset:0 sc1
    buffer_load_dwordx4 v[156:159], v4, s[64:67], s27 offen offset:1024 sc1
    s_add_u32 s27, s27, 2621440
    buffer_load_dwordx4 v[128:131], v4, s[64:67], s27 offen offset:0 sc1
    buffer_load_dwordx4 v[160:163], v4, s[64:67], s27 offen offset:1024 sc1
    s_add_u32 s27, s27, 2621440
    buffer_load_dwordx4 v[132:135], v4, s[64:67], s27 offen offset:0 sc1
    buffer_load_dwordx4 v[164:167], v4, s[64:67], s27 offen offset:1024 sc1
    s_add_u32 s27, s27, 2621440
    buffer_load_dwordx4 v[136:139], v4, s[64:67], s27 offen offset:0 sc1
    buffer_load_dwordx4 v[168:171], v4, s[64:67], s27 offen offset:1024 sc1
    s_add_u32 s27, s27, 2621440
    buffer_load_dwordx4 v[140:143], v4, s[64:67], s27 offen offset:0 sc1
    buffer_load_dwordx4 v[172:175], v4, s[64:67], s27 offen offset:1024 sc1
    s_cmp_lg_u32 s5, 0
    s_cbranch_scc1 sequential_preLN__ssm_conv_h3__dense_activation_relu__prompt_kernel_skip45
    buffer_load_dwordx2 v[176:177], v4, s[64:67], s28 offen offset:8 sc1
    s_add_u32 s29, s28, 4096
    buffer_load_dwordx2 v[178:179], v4, s[64:67], s29 offen offset:8 sc1
    s_add_u32 s28, s28, 2621440
    buffer_load_dwordx2 v[180:181], v4, s[64:67], s28 offen offset:8 sc1
    s_add_u32 s29, s28, 4096
    buffer_load_dwordx2 v[182:183], v4, s[64:67], s29 offen offset:8 sc1
    s_add_u32 s28, s28, 2621440
    buffer_load_dwordx2 v[184:185], v4, s[64:67], s28 offen offset:8 sc1
    s_add_u32 s29, s28, 4096
    buffer_load_dwordx2 v[186:187], v4, s[64:67], s29 offen offset:8 sc1
    s_add_u32 s28, s28, 2621440
    buffer_load_dwordx2 v[188:189], v4, s[64:67], s28 offen offset:8 sc1
    s_add_u32 s29, s28, 4096
    buffer_load_dwordx2 v[190:191], v4, s[64:67], s29 offen offset:8 sc1
    s_add_u32 s28, s28, 2621440
    buffer_load_dwordx2 v[192:193], v4, s[64:67], s28 offen offset:8 sc1
    s_add_u32 s29, s28, 4096
    buffer_load_dwordx2 v[194:195], v4, s[64:67], s29 offen offset:8 sc1
    s_add_u32 s28, s28, 2621440
    buffer_load_dwordx2 v[196:197], v4, s[64:67], s28 offen offset:8 sc1
    s_add_u32 s29, s28, 4096
    buffer_load_dwordx2 v[198:199], v4, s[64:67], s29 offen offset:8 sc1
    s_add_u32 s28, s28, 2621440
    buffer_load_dwordx2 v[200:201], v4, s[64:67], s28 offen offset:8 sc1
    s_add_u32 s29, s28, 4096
    buffer_load_dwordx2 v[202:203], v4, s[64:67], s29 offen offset:8 sc1
    s_add_u32 s28, s28, 2621440
    buffer_load_dwordx2 v[204:205], v4, s[64:67], s28 offen offset:8 sc1
    s_add_u32 s29, s28, 4096
    buffer_load_dwordx2 v[206:207], v4, s[64:67], s29 offen offset:8 sc1
sequential_preLN__ssm_conv_h3__dense_activation_relu__prompt_kernel_skip45:
    s_waitcnt lgkmcnt(0)
    s_waitcnt vmcnt(15)
    v_lshlrev_b32 v40, 16, v112
    v_and_b32 v41, 0xffff0000, v112
    v_lshlrev_b32 v42, 16, v113
    v_and_b32 v43, 0xffff0000, v113
    v_lshlrev_b32 v44, 16, v114
    v_and_b32 v45, 0xffff0000, v114
    v_lshlrev_b32 v46, 16, v115
    v_and_b32 v47, 0xffff0000, v115
    s_waitcnt vmcnt(13)
    v_lshlrev_b32 v48, 16, v116
    v_and_b32 v49, 0xffff0000, v116
    v_pk_add_f32 v[40:41], v[40:41], v[48:49]
    v_lshlrev_b32 v48, 16, v117
    v_and_b32 v49, 0xffff0000, v117
    v_pk_add_f32 v[42:43], v[42:43], v[48:49]
    v_lshlrev_b32 v48, 16, v118
    v_and_b32 v49, 0xffff0000, v118
    v_pk_add_f32 v[44:45], v[44:45], v[48:49]
    v_lshlrev_b32 v48, 16, v119
    v_and_b32 v49, 0xffff0000, v119
    v_pk_add_f32 v[46:47], v[46:47], v[48:49]
    s_waitcnt vmcnt(11)
    v_lshlrev_b32 v48, 16, v120
    v_and_b32 v49, 0xffff0000, v120
    v_pk_add_f32 v[40:41], v[40:41], v[48:49]
    v_lshlrev_b32 v48, 16, v121
    v_and_b32 v49, 0xffff0000, v121
    v_pk_add_f32 v[42:43], v[42:43], v[48:49]
    v_lshlrev_b32 v48, 16, v122
    v_and_b32 v49, 0xffff0000, v122
    v_pk_add_f32 v[44:45], v[44:45], v[48:49]
    v_lshlrev_b32 v48, 16, v123
    v_and_b32 v49, 0xffff0000, v123
    v_pk_add_f32 v[46:47], v[46:47], v[48:49]
    s_waitcnt vmcnt(9)
    v_lshlrev_b32 v48, 16, v124
    v_and_b32 v49, 0xffff0000, v124
    v_pk_add_f32 v[40:41], v[40:41], v[48:49]
    v_lshlrev_b32 v48, 16, v125
    v_and_b32 v49, 0xffff0000, v125
    v_pk_add_f32 v[42:43], v[42:43], v[48:49]
    v_lshlrev_b32 v48, 16, v126
    v_and_b32 v49, 0xffff0000, v126
    v_pk_add_f32 v[44:45], v[44:45], v[48:49]
    v_lshlrev_b32 v48, 16, v127
    v_and_b32 v49, 0xffff0000, v127
    v_pk_add_f32 v[46:47], v[46:47], v[48:49]
    s_waitcnt vmcnt(7)
    v_lshlrev_b32 v48, 16, v128
    v_and_b32 v49, 0xffff0000, v128
    v_pk_add_f32 v[40:41], v[40:41], v[48:49]
    v_lshlrev_b32 v48, 16, v129
    v_and_b32 v49, 0xffff0000, v129
    v_pk_add_f32 v[42:43], v[42:43], v[48:49]
    v_lshlrev_b32 v48, 16, v130
    v_and_b32 v49, 0xffff0000, v130
    v_pk_add_f32 v[44:45], v[44:45], v[48:49]
    v_lshlrev_b32 v48, 16, v131
    v_and_b32 v49, 0xffff0000, v131
    v_pk_add_f32 v[46:47], v[46:47], v[48:49]
    s_waitcnt vmcnt(5)
    v_lshlrev_b32 v48, 16, v132
    v_and_b32 v49, 0xffff0000, v132
    v_pk_add_f32 v[40:41], v[40:41], v[48:49]
    v_lshlrev_b32 v48, 16, v133
    v_and_b32 v49, 0xffff0000, v133
    v_pk_add_f32 v[42:43], v[42:43], v[48:49]
    v_lshlrev_b32 v48, 16, v134
    v_and_b32 v49, 0xffff0000, v134
    v_pk_add_f32 v[44:45], v[44:45], v[48:49]
    v_lshlrev_b32 v48, 16, v135
    v_and_b32 v49, 0xffff0000, v135
    v_pk_add_f32 v[46:47], v[46:47], v[48:49]
    s_waitcnt vmcnt(3)
    v_lshlrev_b32 v48, 16, v136
    v_and_b32 v49, 0xffff0000, v136
    v_pk_add_f32 v[40:41], v[40:41], v[48:49]
    v_lshlrev_b32 v48, 16, v137
    v_and_b32 v49, 0xffff0000, v137
    v_pk_add_f32 v[42:43], v[42:43], v[48:49]
    v_lshlrev_b32 v48, 16, v138
    v_and_b32 v49, 0xffff0000, v138
    v_pk_add_f32 v[44:45], v[44:45], v[48:49]
    v_lshlrev_b32 v48, 16, v139
    v_and_b32 v49, 0xffff0000, v139
    v_pk_add_f32 v[46:47], v[46:47], v[48:49]
    s_waitcnt vmcnt(1)
    v_lshlrev_b32 v48, 16, v140
    v_and_b32 v49, 0xffff0000, v140
    v_pk_add_f32 v[40:41], v[40:41], v[48:49]
    v_lshlrev_b32 v48, 16, v141
    v_and_b32 v49, 0xffff0000, v141
    v_pk_add_f32 v[42:43], v[42:43], v[48:49]
    v_lshlrev_b32 v48, 16, v142
    v_and_b32 v49, 0xffff0000, v142
    v_pk_add_f32 v[44:45], v[44:45], v[48:49]
    v_lshlrev_b32 v48, 16, v143
    v_and_b32 v49, 0xffff0000, v143
    v_pk_add_f32 v[46:47], v[46:47], v[48:49]
    v_cvt_pk_bf16_f32 v50, v40, v41
    v_lshlrev_b32 v40, 16, v50
    v_and_b32 v41, 0xffff0000, v50
    v_lshlrev_b32 v48, 16, v20
    v_and_b32 v49, 0xffff0000, v20
    v_pk_add_f32 v[40:41], v[40:41], v[48:49]
    v_cvt_pk_bf16_f32 v52, v40, v41
    v_cvt_pk_bf16_f32 v50, v42, v43
    v_lshlrev_b32 v42, 16, v50
    v_and_b32 v43, 0xffff0000, v50
    v_lshlrev_b32 v48, 16, v21
    v_and_b32 v49, 0xffff0000, v21
    v_pk_add_f32 v[42:43], v[42:43], v[48:49]
    v_cvt_pk_bf16_f32 v53, v42, v43
    v_cvt_pk_bf16_f32 v50, v44, v45
    v_lshlrev_b32 v44, 16, v50
    v_and_b32 v45, 0xffff0000, v50
    v_lshlrev_b32 v48, 16, v22
    v_and_b32 v49, 0xffff0000, v22
    v_pk_add_f32 v[44:45], v[44:45], v[48:49]
    v_cvt_pk_bf16_f32 v54, v44, v45
    v_cvt_pk_bf16_f32 v50, v46, v47
    v_lshlrev_b32 v46, 16, v50
    v_and_b32 v47, 0xffff0000, v50
    v_lshlrev_b32 v48, 16, v23
    v_and_b32 v49, 0xffff0000, v23
    v_pk_add_f32 v[46:47], v[46:47], v[48:49]
    v_cvt_pk_bf16_f32 v55, v46, v47
    buffer_store_dwordx4 v[52:55], v10, s[68:71], s25 offen
    s_add_u32 s25, s25, 18432
    s_waitcnt vmcnt(1)
    v_lshlrev_b32 v40, 16, v144
    v_and_b32 v41, 0xffff0000, v144
    v_lshlrev_b32 v42, 16, v145
    v_and_b32 v43, 0xffff0000, v145
    v_lshlrev_b32 v44, 16, v146
    v_and_b32 v45, 0xffff0000, v146
    v_lshlrev_b32 v46, 16, v147
    v_and_b32 v47, 0xffff0000, v147
    v_lshlrev_b32 v48, 16, v148
    v_and_b32 v49, 0xffff0000, v148
    v_pk_add_f32 v[40:41], v[40:41], v[48:49]
    v_lshlrev_b32 v48, 16, v149
    v_and_b32 v49, 0xffff0000, v149
    v_pk_add_f32 v[42:43], v[42:43], v[48:49]
    v_lshlrev_b32 v48, 16, v150
    v_and_b32 v49, 0xffff0000, v150
    v_pk_add_f32 v[44:45], v[44:45], v[48:49]
    v_lshlrev_b32 v48, 16, v151
    v_and_b32 v49, 0xffff0000, v151
    v_pk_add_f32 v[46:47], v[46:47], v[48:49]
    v_lshlrev_b32 v48, 16, v152
    v_and_b32 v49, 0xffff0000, v152
    v_pk_add_f32 v[40:41], v[40:41], v[48:49]
    v_lshlrev_b32 v48, 16, v153
    v_and_b32 v49, 0xffff0000, v153
    v_pk_add_f32 v[42:43], v[42:43], v[48:49]
    v_lshlrev_b32 v48, 16, v154
    v_and_b32 v49, 0xffff0000, v154
    v_pk_add_f32 v[44:45], v[44:45], v[48:49]
    v_lshlrev_b32 v48, 16, v155
    v_and_b32 v49, 0xffff0000, v155
    v_pk_add_f32 v[46:47], v[46:47], v[48:49]
    v_lshlrev_b32 v48, 16, v156
    v_and_b32 v49, 0xffff0000, v156
    v_pk_add_f32 v[40:41], v[40:41], v[48:49]
    v_lshlrev_b32 v48, 16, v157
    v_and_b32 v49, 0xffff0000, v157
    v_pk_add_f32 v[42:43], v[42:43], v[48:49]
    v_lshlrev_b32 v48, 16, v158
    v_and_b32 v49, 0xffff0000, v158
    v_pk_add_f32 v[44:45], v[44:45], v[48:49]
    v_lshlrev_b32 v48, 16, v159
    v_and_b32 v49, 0xffff0000, v159
    v_pk_add_f32 v[46:47], v[46:47], v[48:49]
    v_lshlrev_b32 v48, 16, v160
    v_and_b32 v49, 0xffff0000, v160
    v_pk_add_f32 v[40:41], v[40:41], v[48:49]
    v_lshlrev_b32 v48, 16, v161
    v_and_b32 v49, 0xffff0000, v161
    v_pk_add_f32 v[42:43], v[42:43], v[48:49]
    v_lshlrev_b32 v48, 16, v162
    v_and_b32 v49, 0xffff0000, v162
    v_pk_add_f32 v[44:45], v[44:45], v[48:49]
    v_lshlrev_b32 v48, 16, v163
    v_and_b32 v49, 0xffff0000, v163
    v_pk_add_f32 v[46:47], v[46:47], v[48:49]
    v_lshlrev_b32 v48, 16, v164
    v_and_b32 v49, 0xffff0000, v164
    v_pk_add_f32 v[40:41], v[40:41], v[48:49]
    v_lshlrev_b32 v48, 16, v165
    v_and_b32 v49, 0xffff0000, v165
    v_pk_add_f32 v[42:43], v[42:43], v[48:49]
    v_lshlrev_b32 v48, 16, v166
    v_and_b32 v49, 0xffff0000, v166
    v_pk_add_f32 v[44:45], v[44:45], v[48:49]
    v_lshlrev_b32 v48, 16, v167
    v_and_b32 v49, 0xffff0000, v167
    v_pk_add_f32 v[46:47], v[46:47], v[48:49]
    v_lshlrev_b32 v48, 16, v168
    v_and_b32 v49, 0xffff0000, v168
    v_pk_add_f32 v[40:41], v[40:41], v[48:49]
    v_lshlrev_b32 v48, 16, v169
    v_and_b32 v49, 0xffff0000, v169
    v_pk_add_f32 v[42:43], v[42:43], v[48:49]
    v_lshlrev_b32 v48, 16, v170
    v_and_b32 v49, 0xffff0000, v170
    v_pk_add_f32 v[44:45], v[44:45], v[48:49]
    v_lshlrev_b32 v48, 16, v171
    v_and_b32 v49, 0xffff0000, v171
    v_pk_add_f32 v[46:47], v[46:47], v[48:49]
    v_lshlrev_b32 v48, 16, v172
    v_and_b32 v49, 0xffff0000, v172
    v_pk_add_f32 v[40:41], v[40:41], v[48:49]
    v_lshlrev_b32 v48, 16, v173
    v_and_b32 v49, 0xffff0000, v173
    v_pk_add_f32 v[42:43], v[42:43], v[48:49]
    v_lshlrev_b32 v48, 16, v174
    v_and_b32 v49, 0xffff0000, v174
    v_pk_add_f32 v[44:45], v[44:45], v[48:49]
    v_lshlrev_b32 v48, 16, v175
    v_and_b32 v49, 0xffff0000, v175
    v_pk_add_f32 v[46:47], v[46:47], v[48:49]
    v_cvt_pk_bf16_f32 v50, v40, v41
    v_lshlrev_b32 v40, 16, v50
    v_and_b32 v41, 0xffff0000, v50
    v_lshlrev_b32 v48, 16, v24
    v_and_b32 v49, 0xffff0000, v24
    v_pk_add_f32 v[40:41], v[40:41], v[48:49]
    v_cvt_pk_bf16_f32 v56, v40, v41
    v_cvt_pk_bf16_f32 v50, v42, v43
    v_lshlrev_b32 v42, 16, v50
    v_and_b32 v43, 0xffff0000, v50
    v_lshlrev_b32 v48, 16, v25
    v_and_b32 v49, 0xffff0000, v25
    v_pk_add_f32 v[42:43], v[42:43], v[48:49]
    v_cvt_pk_bf16_f32 v57, v42, v43
    v_cvt_pk_bf16_f32 v50, v44, v45
    v_lshlrev_b32 v44, 16, v50
    v_and_b32 v45, 0xffff0000, v50
    v_lshlrev_b32 v48, 16, v26
    v_and_b32 v49, 0xffff0000, v26
    v_pk_add_f32 v[44:45], v[44:45], v[48:49]
    v_cvt_pk_bf16_f32 v58, v44, v45
    v_cvt_pk_bf16_f32 v50, v46, v47
    v_lshlrev_b32 v46, 16, v50
    v_and_b32 v47, 0xffff0000, v50
    v_lshlrev_b32 v48, 16, v27
    v_and_b32 v49, 0xffff0000, v27
    v_pk_add_f32 v[46:47], v[46:47], v[48:49]
    v_cvt_pk_bf16_f32 v59, v46, v47
    buffer_store_dwordx4 v[56:59], v10, s[68:71], s25 offen
    s_cmp_lg_u32 s5, 0
    s_cbranch_scc1 sequential_preLN__ssm_conv_h3__dense_activation_relu__prompt_kernel_skip46
    v_lshlrev_b32 v40, 16, v176
    v_and_b32 v41, 0xffff0000, v176
    v_lshlrev_b32 v42, 16, v177
    v_and_b32 v43, 0xffff0000, v177
    v_lshlrev_b32 v44, 16, v178
    v_and_b32 v45, 0xffff0000, v178
    v_lshlrev_b32 v46, 16, v179
    v_and_b32 v47, 0xffff0000, v179
    v_lshlrev_b32 v48, 16, v180
    v_and_b32 v49, 0xffff0000, v180
    v_pk_add_f32 v[40:41], v[40:41], v[48:49]
    v_lshlrev_b32 v48, 16, v181
    v_and_b32 v49, 0xffff0000, v181
    v_pk_add_f32 v[42:43], v[42:43], v[48:49]
    v_lshlrev_b32 v48, 16, v182
    v_and_b32 v49, 0xffff0000, v182
    v_pk_add_f32 v[44:45], v[44:45], v[48:49]
    v_lshlrev_b32 v48, 16, v183
    v_and_b32 v49, 0xffff0000, v183
    v_pk_add_f32 v[46:47], v[46:47], v[48:49]
    v_lshlrev_b32 v48, 16, v184
    v_and_b32 v49, 0xffff0000, v184
    v_pk_add_f32 v[40:41], v[40:41], v[48:49]
    v_lshlrev_b32 v48, 16, v185
    v_and_b32 v49, 0xffff0000, v185
    v_pk_add_f32 v[42:43], v[42:43], v[48:49]
    v_lshlrev_b32 v48, 16, v186
    v_and_b32 v49, 0xffff0000, v186
    v_pk_add_f32 v[44:45], v[44:45], v[48:49]
    v_lshlrev_b32 v48, 16, v187
    v_and_b32 v49, 0xffff0000, v187
    v_pk_add_f32 v[46:47], v[46:47], v[48:49]
    v_lshlrev_b32 v48, 16, v188
    v_and_b32 v49, 0xffff0000, v188
    v_pk_add_f32 v[40:41], v[40:41], v[48:49]
    v_lshlrev_b32 v48, 16, v189
    v_and_b32 v49, 0xffff0000, v189
    v_pk_add_f32 v[42:43], v[42:43], v[48:49]
    v_lshlrev_b32 v48, 16, v190
    v_and_b32 v49, 0xffff0000, v190
    v_pk_add_f32 v[44:45], v[44:45], v[48:49]
    v_lshlrev_b32 v48, 16, v191
    v_and_b32 v49, 0xffff0000, v191
    v_pk_add_f32 v[46:47], v[46:47], v[48:49]
    v_lshlrev_b32 v48, 16, v192
    v_and_b32 v49, 0xffff0000, v192
    v_pk_add_f32 v[40:41], v[40:41], v[48:49]
    v_lshlrev_b32 v48, 16, v193
    v_and_b32 v49, 0xffff0000, v193
    v_pk_add_f32 v[42:43], v[42:43], v[48:49]
    v_lshlrev_b32 v48, 16, v194
    v_and_b32 v49, 0xffff0000, v194
    v_pk_add_f32 v[44:45], v[44:45], v[48:49]
    v_lshlrev_b32 v48, 16, v195
    v_and_b32 v49, 0xffff0000, v195
    v_pk_add_f32 v[46:47], v[46:47], v[48:49]
    v_lshlrev_b32 v48, 16, v196
    v_and_b32 v49, 0xffff0000, v196
    v_pk_add_f32 v[40:41], v[40:41], v[48:49]
    v_lshlrev_b32 v48, 16, v197
    v_and_b32 v49, 0xffff0000, v197
    v_pk_add_f32 v[42:43], v[42:43], v[48:49]
    v_lshlrev_b32 v48, 16, v198
    v_and_b32 v49, 0xffff0000, v198
    v_pk_add_f32 v[44:45], v[44:45], v[48:49]
    v_lshlrev_b32 v48, 16, v199
    v_and_b32 v49, 0xffff0000, v199
    v_pk_add_f32 v[46:47], v[46:47], v[48:49]
    v_lshlrev_b32 v48, 16, v200
    v_and_b32 v49, 0xffff0000, v200
    v_pk_add_f32 v[40:41], v[40:41], v[48:49]
    v_lshlrev_b32 v48, 16, v201
    v_and_b32 v49, 0xffff0000, v201
    v_pk_add_f32 v[42:43], v[42:43], v[48:49]
    v_lshlrev_b32 v48, 16, v202
    v_and_b32 v49, 0xffff0000, v202
    v_pk_add_f32 v[44:45], v[44:45], v[48:49]
    v_lshlrev_b32 v48, 16, v203
    v_and_b32 v49, 0xffff0000, v203
    v_pk_add_f32 v[46:47], v[46:47], v[48:49]
    v_lshlrev_b32 v48, 16, v204
    v_and_b32 v49, 0xffff0000, v204
    v_pk_add_f32 v[40:41], v[40:41], v[48:49]
    v_lshlrev_b32 v48, 16, v205
    v_and_b32 v49, 0xffff0000, v205
    v_pk_add_f32 v[42:43], v[42:43], v[48:49]
    v_lshlrev_b32 v48, 16, v206
    v_and_b32 v49, 0xffff0000, v206
    v_pk_add_f32 v[44:45], v[44:45], v[48:49]
    v_lshlrev_b32 v48, 16, v207
    v_and_b32 v49, 0xffff0000, v207
    v_pk_add_f32 v[46:47], v[46:47], v[48:49]
    v_cvt_pk_bf16_f32 v50, v40, v41
    v_lshlrev_b32 v40, 16, v50
    v_and_b32 v41, 0xffff0000, v50
    v_lshlrev_b32 v48, 16, v28
    v_and_b32 v49, 0xffff0000, v28
    v_pk_add_f32 v[40:41], v[40:41], v[48:49]
    v_cvt_pk_bf16_f32 v60, v40, v41
    v_cvt_pk_bf16_f32 v50, v42, v43
    v_lshlrev_b32 v42, 16, v50
    v_and_b32 v43, 0xffff0000, v50
    v_lshlrev_b32 v48, 16, v29
    v_and_b32 v49, 0xffff0000, v29
    v_pk_add_f32 v[42:43], v[42:43], v[48:49]
    v_cvt_pk_bf16_f32 v61, v42, v43
    v_cvt_pk_bf16_f32 v50, v44, v45
    v_lshlrev_b32 v44, 16, v50
    v_and_b32 v45, 0xffff0000, v50
    v_lshlrev_b32 v48, 16, v30
    v_and_b32 v49, 0xffff0000, v30
    v_pk_add_f32 v[44:45], v[44:45], v[48:49]
    v_cvt_pk_bf16_f32 v62, v44, v45
    v_cvt_pk_bf16_f32 v50, v46, v47
    v_lshlrev_b32 v46, 16, v50
    v_and_b32 v47, 0xffff0000, v50
    v_lshlrev_b32 v48, 16, v31
    v_and_b32 v49, 0xffff0000, v31
    v_pk_add_f32 v[46:47], v[46:47], v[48:49]
    v_cvt_pk_bf16_f32 v63, v46, v47
    buffer_store_dwordx4 v[60:63], v10, s[68:71], s26 offen
sequential_preLN__ssm_conv_h3__dense_activation_relu__prompt_kernel_skip46:
sequential_preLN__ssm_conv_h3__dense_activation_relu__prompt_kernel_end1:
    s_endpgm
s_endpgm
.p2align 8
.fill 4096, 4, 0xbf810000
.section .rodata,"a"
.p2align 6
.amdhsa_kernel sequential_preLN__ssm_conv_h3__dense_activation_relu__prompt_kernel
  .amdhsa_next_free_vgpr 508
  .amdhsa_next_free_sgpr 102
  .amdhsa_accum_offset 256
  .amdhsa_group_segment_fixed_size 0
  .amdhsa_kernarg_size 96
  .amdhsa_user_sgpr_count 2
  .amdhsa_user_sgpr_kernarg_segment_ptr 1
  .amdhsa_system_sgpr_workgroup_id_x 1
  .amdhsa_float_denorm_mode_32 3
.end_amdhsa_kernel
```
